```python
import torch

def _softmax(x, axis=-1):
    return torch.softmax(x, dim=axis)
def _gelu(x):
    return torch.nn.functional.gelu(x, approximate="tanh")
def _silu(x):
    return torch.nn.functional.silu(x)
def _sigmoid(x):
    return torch.sigmoid(x)
def _layernorm(x, axis=-1, eps=1e-5):
    m = x.mean(dim=axis, keepdim=True)
    v = x.var(dim=axis, keepdim=True, unbiased=False)
    return (x - m) / torch.sqrt(v + eps)
def _scatter_add(tgt, idx, src, axis=0):
    return tgt.clone().index_add_(axis, idx, src)
def _segment_sum(src, seg, n):
    out = torch.zeros((n,) + src.shape[1:], dtype=src.dtype)
    return out.index_add_(0, seg, src)
def _pad(x, pw):
    flat = tuple(v for pair in reversed(pw) for v in pair)
    return torch.nn.functional.pad(x, flat)

kernel_name = 'sequential_preLN__sliding_block__moe_arch_mod__prompt'

def setup_inputs():

    _w = (lambda a: (lambda t: t.to(torch.bfloat16) if t.is_floating_point() else t)(torch.as_tensor(a)))
    def _A_setup():
        B, S, D = 1, 2048, 512
        return {
            "x": _w((lambda *s: torch.randn(*s, dtype=torch.bfloat16) * 0.05)(B, S, D)),
            "wqkv": _w((lambda *s: torch.randn(*s, dtype=torch.bfloat16) * 0.05)(D, 3 * D)),
            "wo": _w((lambda *s: torch.randn(*s, dtype=torch.bfloat16) * 0.05)(D, D)),
        }
    _A_in = _A_setup()

    def _B_setup():
        B, S, D, F, C = 1, 2048, 512, 1792, 1
        return {
            "x": _w((lambda *s: torch.randn(*s, dtype=torch.bfloat16) * 0.05)(B, S, D)),
            "w_r": _w((lambda *s: torch.randn(*s, dtype=torch.bfloat16) * 0.05)(D)),
            "w_gate": _w((lambda *s: torch.randn(*s, dtype=torch.bfloat16) * 0.05)(D, F)),
            "w_up": _w((lambda *s: torch.randn(*s, dtype=torch.bfloat16) * 0.05)(D, F)),
            "w_down": _w((lambda *s: torch.randn(*s, dtype=torch.bfloat16) * 0.05)(F, D)),
        }
    _B_in = _B_setup()

    return {
        "A_x": _A_in["x"],
        "A_wqkv": _A_in["wqkv"],
        "A_wo": _A_in["wo"],
        "B_x": _B_in["x"],
        "B_w_r": _B_in["w_r"],
        "B_w_gate": _B_in["w_gate"],
        "B_w_up": _B_in["w_up"],
        "B_w_down": _B_in["w_down"],
    }

def reference(A_x, A_wqkv, A_wo, B_x, B_w_r, B_w_gate, B_w_up, B_w_down):
    def _A_ref(x, wqkv, wo):
        B, S, D = x.shape
        H = 32; Dh = D // H; W = 256
        qkv = (lambda x, *d: x.permute(*d))((x @ wqkv).reshape(B, S, 3, H, Dh), 2, 0, 3, 1, 4)
        q, k, v = qkv[0], qkv[1], qkv[2]
        scores = torch.einsum("bhqd,bhkd->bhqk", q, k) * (Dh ** -0.5)
        idx = torch.arange(S)
        mask = (idx[:, None] - idx[None, :] >= 0) & (idx[:, None] - idx[None, :] < W)
        scores = torch.where(mask[None, None], scores, -1e9)
        p = _softmax(scores, axis=-1)
        o = torch.einsum("bhqk,bhkd->bhqd", p, v)
        return (lambda x, *d: x.permute(*d))(o, 0, 2, 1, 3).reshape(B, S, D) @ wo

    def _B_ref(x, w_r, w_gate, w_up, w_down):
        B, S, D = x.shape
        C = 1
        r = x @ w_r
        idx = torch.argsort(-r, axis=-1)[:, :C]
        idx_e = (lambda x, n, axis: torch.repeat_interleave(x, n, dim=axis))(idx.reshape(B, C, 1), D, axis=2)
        x_sel = (lambda x, i, axis: torch.take_along_dim(x, i, dim=axis))(x, idx_e, axis=1)
        g = _silu(x_sel @ w_gate)
        u = x_sel @ w_up
        y = (g * u) @ w_down
        r_sel = _sigmoid((lambda x, i, axis: torch.take_along_dim(x, i, dim=axis))(r, idx, axis=1))
        y = y * r_sel.reshape(B, C, 1)
        b_off = (torch.arange(B) * S).reshape(B, 1)
        flat_idx = (idx + b_off).reshape(B * C)
        zero = (x * 0.0).reshape(B * S, D)
        upd = _scatter_add(zero, flat_idx, y.reshape(B * C, D), axis=0)
        return x + upd.reshape(B, S, D)

    x = A_x
    h = x + _A_ref(_layernorm(x, axis=-1), A_wqkv, A_wo)
    h2 = h + _B_ref(_layernorm(h, axis=-1), B_w_r, B_w_gate, B_w_up, B_w_down)
    return h2
```

```asm
; @launch grid=(256,1,1) block=(512,1,1) lds=163840
.amdgcn_target "amdgcn-amd-amdhsa--gfx950"
.text
.globl sequential_preLN__sliding_block__moe_arch_mod__prompt_kernel
.p2align 8
.type sequential_preLN__sliding_block__moe_arch_mod__prompt_kernel,@function
sequential_preLN__sliding_block__moe_arch_mod__prompt_kernel:
L_start:
s_load_dwordx16 s[36:51], s[0:1], 0
s_load_dwordx2 s[52:53], s[0:1], 64
s_load_dwordx2 s[54:55], s[0:1], 80
s_cmp_ge_u32 s2, 256
s_cbranch_scc1 L_end

v_lshrrev_b32 v1, 6, v0
v_and_b32 v0, 63, v0
s_and_b32 s56, s2, 7
v_readfirstlane_b32 s3, v1
s_lshr_b32 s57, s2, 3
s_and_b32 s5, s56, 3
s_lshl_b32 s5, s5, 1
s_and_b32 s58, s57, 1
s_or_b32 s5, s5, s58
s_lshr_b32 s4, s56, 2
s_lshl_b32 s4, s4, 4
s_lshr_b32 s58, s57, 1
s_or_b32 s4, s4, s58
s_lshl_b32 s7, s5, 2
s_add_u32 s7, s7, s4
s_cmp_lt_u32 s3, 4
s_cbranch_scc1 L_compute
s_setprio 0
s_sub_u32 s3, s3, 4
v_lshrrev_b32 v1, 3, v0
v_and_b32 v2, 7, v0
v_lshrrev_b32 v3, 4, v0
v_xor_b32 v10, v2, v3
v_lshlrev_b32 v11, 10, v1
v_lshl_add_u32 v12, v10, 4, v11
v_xor_b32 v13, 64, v12
v_add_u32 v13, 8192, v13
v_and_b32 v10, 1, v3
v_lshlrev_b32 v10, 2, v10
v_xor_b32 v10, v10, v2
v_mul_u32_u24 v11, 3072, v1
v_lshl_add_u32 v14, v10, 4, v11
v_add_u32 v15, 24576, v14
s_lshl_b32 s96, s4, 16
s_lshl_b32 s60, s3, 14
s_add_u32 s96, s96, s60
s_lshl_b32 s97, s5, 7
s_mul_i32 s60, s3, 49152
s_add_u32 s97, s97, s60
s_lshl_b32 s98, s3, 11
s_mov_b32 s10, 0x200000
s_mov_b32 s11, 0x00020000
s_mov_b32 s14, 0x180000
s_mov_b32 s15, 0x00020000
s_waitcnt lgkmcnt(0)
s_mov_b64 s[8:9], s[36:37]
s_mov_b64 s[12:13], s[38:39]
s_add_u32 s99, s7, 0
s_and_b32 s99, s99, 7
s_lshl_b32 s99, s99, 7
s_add_u32 s99, s99, s96
s_add_u32 m0, s98, 0
s_nop 0
buffer_load_dwordx4 v12, s[8:11], s99 offen lds
s_add_u32 m0, s98, 1024
s_nop 0
buffer_load_dwordx4 v13, s[8:11], s99 offen lds
s_add_u32 s99, s7, 0
s_and_b32 s99, s99, 7
s_mul_i32 s99, s99, 196608
s_add_u32 s99, s99, s97
s_add_u32 m0, s98, 64512
s_nop 0
buffer_load_dwordx4 v14, s[12:15], s99 offen offset:1024 lds
s_add_u32 m0, s98, 65536
s_nop 0
buffer_load_dwordx4 v15, s[12:15], s99 offen offset:1024 lds
s_add_u32 m0, s98, 71680
s_nop 0
buffer_load_dwordx4 v14, s[12:15], s99 offen offset:2048 lds
s_add_u32 m0, s98, 72704
s_nop 0
buffer_load_dwordx4 v15, s[12:15], s99 offen offset:2048 lds
s_add_u32 s99, s7, 1
s_and_b32 s99, s99, 7
s_lshl_b32 s99, s99, 7
s_add_u32 s99, s99, s96
s_add_u32 m0, s98, 8192
s_nop 0
buffer_load_dwordx4 v12, s[8:11], s99 offen lds
s_add_u32 m0, s98, 9216
s_nop 0
buffer_load_dwordx4 v13, s[8:11], s99 offen lds
s_add_u32 s99, s7, 1
s_and_b32 s99, s99, 7
s_mul_i32 s99, s99, 196608
s_add_u32 s99, s99, s97
s_add_u32 m0, s98, 80896
s_nop 0
buffer_load_dwordx4 v14, s[12:15], s99 offen offset:1024 lds
s_add_u32 m0, s98, 81920
s_nop 0
buffer_load_dwordx4 v15, s[12:15], s99 offen offset:1024 lds
s_load_dword s6, s[54:55], 0
s_mov_b32 s16, s54
s_mov_b32 s17, s55
s_mov_b32 s18, 16777216
s_mov_b32 s19, 0x00020000
s_mov_b32 s20, s40
s_mov_b32 s21, s41
s_mov_b32 s22, 524288
s_mov_b32 s23, 0x00020000
s_mov_b32 s24, s52
s_mov_b32 s25, s53
s_mov_b32 s26, 2097152
s_mov_b32 s27, 0x00020000
s_mov_b32 s64, 1065369472
s_and_b32 s56, s3, 1
s_lshr_b32 s57, s3, 1
v_lshrrev_b32 v28, 5, v0
v_and_b32 v29, 31, v0
s_lshl_b32 s60, s3, 7
s_add_u32 s60, s60, 155648
v_lshl_add_u32 v126, v29, 2, s60
s_lshl_b32 s60, s56, 5
v_add_u32 v29, s60, v29
v_bfe_u32 v30, v29, 1, 3
v_xor_b32 v30, v30, v28
v_lshlrev_b32 v31, 7, v29
v_lshl_add_u32 v112, v30, 4, v31
s_lshl_b32 s60, s3, 5
v_xor_b32 v112, s60, v112
v_xor_b32 v113, 32, v112
v_xor_b32 v114, 64, v112
v_xor_b32 v115, 96, v112
v_bfe_u32 v29, v0, 2, 2
v_lshl_add_u32 v30, v28, 3, v29
v_lshlrev_b32 v30, 7, v30
v_lshrrev_b32 v29, 1, v29
v_xor_b32 v29, s57, v29
v_lshl_add_u32 v30, v29, 6, v30
v_and_b32 v29, 16, v0
v_lshl_add_u32 v30, v29, 1, v30
v_and_b32 v29, 3, v0
v_lshl_add_u32 v30, v29, 3, v30
s_lshl_b32 s60, s3, 11
s_add_u32 s60, s60, 65536
v_add_u32 v116, s60, v30
v_xor_b32 v117, 2048, v116
v_xor_b32 v118, 4096, v116
v_xor_b32 v119, 6144, v116
v_lshrrev_b32 v29, 1, v0
v_xor_b32 v29, v29, v28
v_and_b32 v29, 1, v29
v_bfe_u32 v30, v0, 2, 1
v_lshl_add_u32 v29, v29, 1, v30
v_mov_b32 v30, 0x3f003f00
v_cmp_eq_u32 vcc, 0, v29
s_nop 1
v_cndmask_b32 v120, 0, v30, vcc
v_cndmask_b32 v121, 0, v30, vcc
v_cmp_eq_u32 vcc, 1, v29
s_nop 1
v_cndmask_b32 v122, 0, v30, vcc
v_cndmask_b32 v123, 0, v30, vcc
v_and_b32 v29, 1, v0
v_mul_u32_u24 v29, 0xaaaa, v29
v_add_u32 v124, 0x4444, v29
s_lshl_b32 s60, s57, 2
s_add_u32 s60, s60, s56
s_lshl_b32 s60, s60, 10
s_add_u32 s60, s60, 147456
v_lshl_add_u32 v125, v0, 4, s60
v_mul_u32_u24 v18, 3584, v0
v_mov_b64 v[76:77], 0
v_mov_b64 v[78:79], 0
v_mov_b64 v[80:81], 0
v_mov_b64 v[82:83], 0
v_mov_b64 v[84:85], 0
v_mov_b64 v[86:87], 0
s_and_b32 s68, s2, 7
s_lshr_b32 s69, s2, 3
s_mul_i32 s59, s68, 28
s_add_u32 s59, s59, s69
s_cmp_ge_u32 s69, 28
s_cselect_b32 s59, 224, s59
s_bitcmp1_b32 s3, 0
s_cselect_b32 s28, s48, s46
s_cselect_b32 s29, s49, s47
s_mov_b32 s30, 1835008
s_mov_b32 s31, 0x00020000
s_mov_b32 s32, s50
s_mov_b32 s33, s51
s_mov_b32 s34, 1835008
s_mov_b32 s35, 0x00020000
s_lshr_b32 s65, s69, 2
s_lshl_b32 s63, s68, 3
s_add_u32 s65, s65, s63
s_and_b32 s66, s69, 3
v_lshrrev_b32 v1, 4, v0
v_and_b32 v2, 15, v0
v_lshlrev_b32 v3, 2, v1
v_xor_b32 v2, v2, v3
v_lshlrev_b32 v1, 10, v1
v_lshl_add_u32 v4, v2, 4, v1
s_lshr_b32 s58, s3, 1
s_add_u32 s58, s58, 1
s_lshl_b32 s57, s58, 17
s_lshl_b32 s60, s66, 8
s_add_u32 s57, s57, s60
s_lshl_b32 s60, s3, 14
s_add_u32 s60, s60, 32768
s_and_b32 s58, s3, 1
s_lshl_b32 s58, s58, 2
s_add_u32 s58, s58, s65
v_bfe_u32 v1, v0, 2, 2
v_lshrrev_b32 v2, 5, v0
v_lshl_add_u32 v2, v2, 2, v1
v_lshlrev_b32 v2, 8, v2
v_xor_b32 v3, s3, v1
v_lshl_add_u32 v2, v3, 6, v2
v_and_b32 v1, 1, v0
v_lshl_add_u32 v2, v1, 5, v2
v_and_b32 v1, 16, v0
v_add_u32 v2, v2, v1
v_and_b32 v1, 2, v0
v_lshl_add_u32 v2, v1, 2, v2
v_lshlrev_b32 v5, 4, v0
v_lshlrev_b32 v3, 2, v0
v_add_u32 v3, 1024, v3
s_add_u32 s63, s3, 0
s_and_b32 s63, s63, 3
s_lshl_b32 s62, s63, 15
v_add_u32 v8, s62, v2
s_lshl_b32 s62, s63, 13
v_add_u32 v72, s62, v5
s_add_u32 s63, s3, 1
s_and_b32 s63, s63, 3
s_lshl_b32 s62, s63, 15
v_add_u32 v9, s62, v2
s_lshl_b32 s62, s63, 13
v_add_u32 v73, s62, v5
s_add_u32 s63, s3, 2
s_and_b32 s63, s63, 3
s_lshl_b32 s62, s63, 15
v_add_u32 v10, s62, v2
s_lshl_b32 s62, s63, 13
v_add_u32 v74, s62, v5
s_add_u32 s63, s3, 3
s_and_b32 s63, s63, 3
s_lshl_b32 s62, s63, 15
v_add_u32 v11, s62, v2
s_lshl_b32 s62, s63, 13
v_add_u32 v75, s62, v5
s_lshl_b32 s62, s66, 8
s_lshl_b32 s63, s3, 6
s_add_u32 s62, s62, s63
v_lshrrev_b32 v1, 5, v0
v_lshl_add_u32 v7, v1, 5, s62
v_and_b32 v1, 31, v0
s_lshl_b32 s63, s65, 5
v_add_u32 v1, s63, v1
v_lshl_add_u32 v6, v1, 10, v7
v_sub_u32 v16, 2047, v1
s_lshl_b32 s62, s65, 11
s_add_u32 s62, s62, 8192
s_lshl_b32 s63, s69, 8

s_add_u32 s63, s63, 196608
s_and_b32 s68, s2, 7
s_lshl_b32 s68, s68, 13
s_add_u32 s63, s63, s68
s_cmp_eq_u32 s3, 0
s_cselect_b32 s62, s62, s63
s_cselect_b32 s63, 15, 1
s_lshl_b32 s68, s59, 6
s_add_u32 s68, s68, 524288
s_cmp_eq_u32 s3, 2
s_cselect_b32 s62, s68, s62
s_cselect_b32 s63, 31, s63
s_cselect_b32 s101, 112, 1
s_lshl_b32 s101, s101, 7
s_lshl_b32 s68, s65, 12
s_lshl_b32 s70, s66, 10
s_add_u32 s68, s68, s70
s_add_u32 s68, s68, 262144
s_cmp_eq_u32 s3, 3
s_cselect_b32 s62, s68, s62
s_cselect_b32 s63, 7, s63
v_min_u32 v19, s63, v0
v_mul_u32_u24 v19, s101, v19
s_mov_b32 s100, s62
s_waitcnt lgkmcnt(0)
s_mul_i32 s6, s6, 0x9E3779B1
s_add_u32 s6, s6, 0x7F4A7C15
s_waitcnt vmcnt(9)
s_add_u32 m0, s98, 88064
s_nop 0
buffer_load_dwordx4 v14, s[12:15], s99 offen offset:2048 lds
s_waitcnt vmcnt(9)
s_add_u32 m0, s98, 89088
s_nop 0
buffer_load_dwordx4 v15, s[12:15], s99 offen offset:2048 lds
s_waitcnt vmcnt(9)
s_add_u32 s99, s7, 2
s_and_b32 s99, s99, 7
s_lshl_b32 s99, s99, 7
s_add_u32 s99, s99, s96
s_add_u32 m0, s98, 16384
s_nop 0
buffer_load_dwordx4 v12, s[8:11], s99 offen lds
s_waitcnt vmcnt(9)
s_add_u32 m0, s98, 17408
s_nop 0
buffer_load_dwordx4 v13, s[8:11], s99 offen lds
s_waitcnt vmcnt(9)
s_add_u32 s99, s7, 2
s_and_b32 s99, s99, 7
s_mul_i32 s99, s99, 196608
s_add_u32 s99, s99, s97
s_add_u32 m0, s98, 97280
s_nop 0
buffer_load_dwordx4 v14, s[12:15], s99 offen offset:1024 lds
s_waitcnt vmcnt(9)
s_barrier
s_add_u32 m0, s98, 98304
s_nop 0
buffer_load_dwordx4 v15, s[12:15], s99 offen offset:1024 lds
ds_read_b128 v[128:131], v112 offset:0
ds_read_b128 v[132:135], v113 offset:0
ds_read_b128 v[136:139], v114 offset:0
ds_read_b128 v[140:143], v115 offset:0
s_waitcnt vmcnt(9)
s_add_u32 m0, s98, 104448
s_nop 0
buffer_load_dwordx4 v14, s[12:15], s99 offen offset:2048 lds
s_waitcnt vmcnt(9)
s_add_u32 m0, s98, 105472
s_nop 0
buffer_load_dwordx4 v15, s[12:15], s99 offen offset:2048 lds
s_waitcnt vmcnt(9)
s_add_u32 s99, s7, 3
s_and_b32 s99, s99, 7
s_lshl_b32 s99, s99, 7
s_add_u32 s99, s99, s96
s_add_u32 m0, s98, 24576
s_nop 0
buffer_load_dwordx4 v12, s[8:11], s99 offen lds
s_waitcnt vmcnt(9)
s_add_u32 m0, s98, 25600
s_nop 0
buffer_load_dwordx4 v13, s[8:11], s99 offen lds
s_waitcnt vmcnt(9)
s_add_u32 s99, s7, 3
s_and_b32 s99, s99, 7
s_mul_i32 s99, s99, 196608
s_add_u32 s99, s99, s97
s_add_u32 m0, s98, 113664
s_nop 0
buffer_load_dwordx4 v14, s[12:15], s99 offen offset:1024 lds
s_waitcnt vmcnt(9)
s_waitcnt lgkmcnt(0)
s_barrier
s_add_u32 m0, s98, 114688
s_nop 0
buffer_load_dwordx4 v15, s[12:15], s99 offen offset:1024 lds
ds_read_b128 v[144:147], v112 offset:8192
ds_read_b128 v[148:151], v113 offset:8192
ds_read_b128 v[152:155], v114 offset:8192
ds_read_b128 v[156:159], v115 offset:8192
s_waitcnt vmcnt(9)
s_add_u32 m0, s98, 120832
s_nop 0
buffer_load_dwordx4 v14, s[12:15], s99 offen offset:2048 lds
s_waitcnt vmcnt(9)
s_add_u32 m0, s98, 121856
s_nop 0
buffer_load_dwordx4 v15, s[12:15], s99 offen offset:2048 lds
s_waitcnt vmcnt(9)
s_add_u32 s99, s7, 4
s_and_b32 s99, s99, 7
s_lshl_b32 s99, s99, 7
s_add_u32 s99, s99, s96
s_add_u32 m0, s98, 32768
s_nop 0
buffer_load_dwordx4 v12, s[8:11], s99 offen lds
s_waitcnt vmcnt(9)
s_add_u32 m0, s98, 33792
s_nop 0
buffer_load_dwordx4 v13, s[8:11], s99 offen lds
s_waitcnt vmcnt(9)
s_add_u32 s99, s7, 5
s_and_b32 s99, s99, 7
s_lshl_b32 s99, s99, 7
s_add_u32 s99, s99, s96
s_add_u32 m0, s98, 40960
s_nop 0
buffer_load_dwordx4 v12, s[8:11], s99 offen lds
s_waitcnt vmcnt(9)
s_waitcnt lgkmcnt(0)
s_barrier
s_add_u32 m0, s98, 41984
s_nop 0
buffer_load_dwordx4 v13, s[8:11], s99 offen lds
ds_read_b128 v[160:163], v112 offset:16384
ds_read_b128 v[164:167], v113 offset:16384
ds_read_b128 v[168:171], v114 offset:16384
ds_read_b128 v[172:175], v115 offset:16384
s_waitcnt vmcnt(9)
s_add_u32 s99, s7, 4
s_and_b32 s99, s99, 7
s_mul_i32 s99, s99, 196608
s_add_u32 s99, s99, s97
s_add_u32 m0, s98, 130048
s_nop 0
buffer_load_dwordx4 v14, s[12:15], s99 offen offset:1024 lds
s_waitcnt vmcnt(9)
s_add_u32 m0, s98, 131072
s_nop 0
buffer_load_dwordx4 v15, s[12:15], s99 offen offset:1024 lds
s_waitcnt vmcnt(9)
s_add_u32 m0, s98, 137216
s_nop 0
buffer_load_dwordx4 v14, s[12:15], s99 offen offset:2048 lds
s_waitcnt vmcnt(9)
s_add_u32 m0, s98, 138240
s_nop 0
buffer_load_dwordx4 v15, s[12:15], s99 offen offset:2048 lds
s_waitcnt vmcnt(9)
s_add_u32 s99, s7, 6
s_and_b32 s99, s99, 7
s_lshl_b32 s99, s99, 7
s_add_u32 s99, s99, s96
s_add_u32 m0, s98, 49152
s_nop 0
buffer_load_dwordx4 v12, s[8:11], s99 offen lds
s_waitcnt vmcnt(9)
s_waitcnt lgkmcnt(0)
s_barrier
s_add_u32 m0, s98, 50176
s_nop 0
buffer_load_dwordx4 v13, s[8:11], s99 offen lds
ds_read_b128 v[176:179], v112 offset:24576
ds_read_b128 v[180:183], v113 offset:24576
ds_read_b128 v[184:187], v114 offset:24576
ds_read_b128 v[188:191], v115 offset:24576
s_waitcnt vmcnt(9)
s_add_u32 s99, s7, 7
s_and_b32 s99, s99, 7
s_lshl_b32 s99, s99, 7
s_add_u32 s99, s99, s96
s_add_u32 m0, s98, 57344
s_nop 0
buffer_load_dwordx4 v12, s[8:11], s99 offen lds
s_waitcnt vmcnt(9)
s_add_u32 m0, s98, 58368
s_nop 0
buffer_load_dwordx4 v13, s[8:11], s99 offen lds
s_waitcnt vmcnt(9)
s_add_u32 s99, s7, 5
s_and_b32 s99, s99, 7
s_mul_i32 s99, s99, 196608
s_add_u32 s99, s99, s97
s_add_u32 m0, s98, 146432
s_nop 0
buffer_load_dwordx4 v14, s[12:15], s99 offen offset:1024 lds
s_waitcnt vmcnt(9)
s_add_u32 m0, s98, 147456
s_nop 0
buffer_load_dwordx4 v15, s[12:15], s99 offen offset:1024 lds
s_waitcnt vmcnt(9)
s_add_u32 m0, s98, 153600
s_nop 0
buffer_load_dwordx4 v14, s[12:15], s99 offen offset:2048 lds
s_waitcnt vmcnt(9)
s_add_u32 m0, s98, 154624
s_nop 0
buffer_load_dwordx4 v15, s[12:15], s99 offen offset:2048 lds
s_waitcnt vmcnt(9)
s_add_u32 s99, s7, 6
s_and_b32 s99, s99, 7
s_mul_i32 s99, s99, 196608
s_add_u32 s99, s99, s97
s_add_u32 m0, s98, 64512
s_nop 0
buffer_load_dwordx4 v14, s[12:15], s99 offen offset:1024 lds
s_waitcnt vmcnt(9)
s_waitcnt lgkmcnt(0)
s_barrier
s_add_u32 m0, s98, 65536
s_nop 0
buffer_load_dwordx4 v15, s[12:15], s99 offen offset:1024 lds
ds_read_b128 v[192:195], v112 offset:32768
ds_read_b128 v[196:199], v113 offset:32768
ds_read_b128 v[200:203], v114 offset:32768
ds_read_b128 v[204:207], v115 offset:32768
ds_read_b128 v[208:211], v112 offset:40960
ds_read_b128 v[212:215], v113 offset:40960
ds_read_b128 v[216:219], v114 offset:40960
ds_read_b128 v[220:223], v115 offset:40960
s_waitcnt vmcnt(9)
s_add_u32 m0, s98, 71680
s_nop 0
buffer_load_dwordx4 v14, s[12:15], s99 offen offset:2048 lds
s_waitcnt vmcnt(9)
s_add_u32 m0, s98, 72704
s_nop 0
buffer_load_dwordx4 v15, s[12:15], s99 offen offset:2048 lds
s_waitcnt vmcnt(9)
s_add_u32 s99, s7, 7
s_and_b32 s99, s99, 7
s_mul_i32 s99, s99, 196608
s_add_u32 s99, s99, s97
s_add_u32 m0, s98, 80896
s_nop 0
buffer_load_dwordx4 v14, s[12:15], s99 offen offset:1024 lds
s_waitcnt vmcnt(9)
s_add_u32 m0, s98, 81920
s_nop 0
buffer_load_dwordx4 v15, s[12:15], s99 offen offset:1024 lds
s_waitcnt vmcnt(9)
s_add_u32 m0, s98, 88064
s_nop 0
buffer_load_dwordx4 v14, s[12:15], s99 offen offset:2048 lds
s_waitcnt vmcnt(9)
s_add_u32 m0, s98, 89088
s_nop 0
buffer_load_dwordx4 v15, s[12:15], s99 offen offset:2048 lds
s_waitcnt vmcnt(9)
s_add_u32 s99, s7, 0
s_and_b32 s99, s99, 7
s_mul_i32 s99, s99, 196608
s_add_u32 s99, s99, s97
s_add_u32 m0, s98, 98304
s_nop 0
buffer_load_dwordx4 v14, s[12:15], s99 offen lds
s_waitcnt vmcnt(9)
s_waitcnt lgkmcnt(0)
s_barrier
s_add_u32 m0, s98, 99328
s_nop 0
buffer_load_dwordx4 v15, s[12:15], s99 offen lds
ds_read_b128 v[224:227], v112 offset:49152
ds_read_b128 v[228:231], v113 offset:49152
ds_read_b128 v[232:235], v114 offset:49152
ds_read_b128 v[236:239], v115 offset:49152
ds_read_b128 v[240:243], v112 offset:57344
ds_read_b128 v[244:247], v113 offset:57344
ds_read_b128 v[248:251], v114 offset:57344
ds_read_b128 v[252:255], v115 offset:57344
s_waitcnt vmcnt(9)
s_add_u32 s99, s7, 1
s_and_b32 s99, s99, 7
s_mul_i32 s99, s99, 196608
s_add_u32 s99, s99, s97
s_add_u32 m0, s98, 106496
s_nop 0
buffer_load_dwordx4 v14, s[12:15], s99 offen lds
s_waitcnt vmcnt(9)
s_add_u32 m0, s98, 107520
s_nop 0
buffer_load_dwordx4 v15, s[12:15], s99 offen lds
s_waitcnt vmcnt(9)
s_add_u32 s99, s7, 2
s_and_b32 s99, s99, 7
s_mul_i32 s99, s99, 196608
s_add_u32 s99, s99, s97
s_add_u32 m0, s98, 114688
s_nop 0
buffer_load_dwordx4 v14, s[12:15], s99 offen lds
s_waitcnt vmcnt(9)
s_waitcnt lgkmcnt(0)
s_barrier
s_add_u32 m0, s98, 115712
s_nop 0
buffer_load_dwordx4 v15, s[12:15], s99 offen lds
s_waitcnt vmcnt(9)
s_add_u32 s99, s7, 3
s_and_b32 s99, s99, 7
s_mul_i32 s99, s99, 196608
s_add_u32 s99, s99, s97
s_add_u32 m0, s98, 122880
s_nop 0
buffer_load_dwordx4 v14, s[12:15], s99 offen lds
s_waitcnt vmcnt(9)
s_add_u32 m0, s98, 123904
s_nop 0
buffer_load_dwordx4 v15, s[12:15], s99 offen lds
s_waitcnt vmcnt(9)
s_add_u32 s99, s7, 4
s_and_b32 s99, s99, 7
s_mul_i32 s99, s99, 196608
s_add_u32 s99, s99, s97
s_add_u32 m0, s98, 0
s_nop 0
buffer_load_dwordx4 v14, s[12:15], s99 offen lds
s_waitcnt vmcnt(9)
s_barrier
s_add_u32 m0, s98, 1024
s_nop 0
buffer_load_dwordx4 v15, s[12:15], s99 offen lds
s_add_u32 s99, s7, 5
s_and_b32 s99, s99, 7
s_mul_i32 s99, s99, 196608
s_add_u32 s99, s99, s97
s_add_u32 m0, s98, 8192
s_nop 0
buffer_load_dwordx4 v14, s[12:15], s99 offen lds
s_add_u32 m0, s98, 9216
s_nop 0
buffer_load_dwordx4 v15, s[12:15], s99 offen lds
s_add_u32 s99, s7, 6
s_and_b32 s99, s99, 7
s_mul_i32 s99, s99, 196608
s_add_u32 s99, s99, s97
s_add_u32 m0, s98, 16384
s_nop 0
buffer_load_dwordx4 v14, s[12:15], s99 offen lds
s_add_u32 m0, s98, 17408
s_nop 0
buffer_load_dwordx4 v15, s[12:15], s99 offen lds
s_add_u32 s99, s7, 7
s_and_b32 s99, s99, 7
s_mul_i32 s99, s99, 196608
s_add_u32 s99, s99, s97
s_add_u32 m0, s98, 24576
s_nop 0
buffer_load_dwordx4 v14, s[12:15], s99 offen lds
s_add_u32 m0, s98, 25600
s_nop 0
buffer_load_dwordx4 v15, s[12:15], s99 offen lds
s_waitcnt vmcnt(8)
s_setprio 1
s_barrier
ds_read_b64_tr_b16 v[32:33], v116 offset:32768
ds_read_b64_tr_b16 v[34:35], v116 offset:33280
ds_read_b64_tr_b16 v[36:37], v117 offset:32768
ds_read_b64_tr_b16 v[38:39], v117 offset:33280
ds_read_b64_tr_b16 v[40:41], v118 offset:32768
ds_read_b64_tr_b16 v[42:43], v118 offset:33280
ds_read_b64_tr_b16 v[44:45], v119 offset:32768
ds_read_b64_tr_b16 v[46:47], v119 offset:33280
ds_read_b64_tr_b16 v[48:49], v116 offset:40960
ds_read_b64_tr_b16 v[50:51], v116 offset:41472
ds_read_b64_tr_b16 v[52:53], v117 offset:40960
ds_read_b64_tr_b16 v[54:55], v117 offset:41472
s_waitcnt lgkmcnt(10)
v_mfma_f32_32x32x16_bf16 v[96:111], v[32:35], v[128:131], 0
s_waitcnt lgkmcnt(8)
v_mfma_f32_32x32x16_bf16 v[96:111], v[36:39], v[132:135], v[96:111]
v_smfmac_f32_16x16x64_bf16 v[76:79], v[120:123], v[32:39], v124
ds_read_b64_tr_b16 v[56:57], v118 offset:40960
ds_read_b64_tr_b16 v[58:59], v118 offset:41472
ds_read_b64_tr_b16 v[60:61], v119 offset:40960
ds_read_b64_tr_b16 v[62:63], v119 offset:41472
s_waitcnt lgkmcnt(10)
v_mfma_f32_32x32x16_bf16 v[96:111], v[40:43], v[136:139], v[96:111]
s_waitcnt lgkmcnt(8)
v_mfma_f32_32x32x16_bf16 v[96:111], v[44:47], v[140:143], v[96:111]
v_smfmac_f32_16x16x64_bf16 v[76:79], v[120:123], v[40:47], v124
ds_read_b64_tr_b16 v[32:33], v116 offset:49152
ds_read_b64_tr_b16 v[34:35], v116 offset:49664
ds_read_b64_tr_b16 v[36:37], v117 offset:49152
ds_read_b64_tr_b16 v[38:39], v117 offset:49664
s_waitcnt lgkmcnt(10)
v_mfma_f32_32x32x16_bf16 v[96:111], v[48:51], v[144:147], v[96:111]
s_waitcnt lgkmcnt(8)
v_mfma_f32_32x32x16_bf16 v[96:111], v[52:55], v[148:151], v[96:111]
v_smfmac_f32_16x16x64_bf16 v[76:79], v[120:123], v[48:55], v124
ds_read_b64_tr_b16 v[40:41], v118 offset:49152
ds_read_b64_tr_b16 v[42:43], v118 offset:49664
ds_read_b64_tr_b16 v[44:45], v119 offset:49152
ds_read_b64_tr_b16 v[46:47], v119 offset:49664
s_waitcnt lgkmcnt(10)
v_mfma_f32_32x32x16_bf16 v[96:111], v[56:59], v[152:155], v[96:111]
s_waitcnt lgkmcnt(8)
v_mfma_f32_32x32x16_bf16 v[96:111], v[60:63], v[156:159], v[96:111]
v_smfmac_f32_16x16x64_bf16 v[76:79], v[120:123], v[56:63], v124
ds_read_b64_tr_b16 v[48:49], v116 offset:57344
ds_read_b64_tr_b16 v[50:51], v116 offset:57856
ds_read_b64_tr_b16 v[52:53], v117 offset:57344
ds_read_b64_tr_b16 v[54:55], v117 offset:57856
s_waitcnt lgkmcnt(10)
v_mfma_f32_32x32x16_bf16 v[96:111], v[32:35], v[160:163], v[96:111]
s_waitcnt lgkmcnt(8)
v_mfma_f32_32x32x16_bf16 v[96:111], v[36:39], v[164:167], v[96:111]
v_smfmac_f32_16x16x64_bf16 v[76:79], v[120:123], v[32:39], v124
ds_read_b64_tr_b16 v[56:57], v118 offset:57344
ds_read_b64_tr_b16 v[58:59], v118 offset:57856
ds_read_b64_tr_b16 v[60:61], v119 offset:57344
ds_read_b64_tr_b16 v[62:63], v119 offset:57856
s_waitcnt lgkmcnt(10)
v_mfma_f32_32x32x16_bf16 v[96:111], v[40:43], v[168:171], v[96:111]
s_waitcnt lgkmcnt(8)
v_mfma_f32_32x32x16_bf16 v[96:111], v[44:47], v[172:175], v[96:111]
v_smfmac_f32_16x16x64_bf16 v[76:79], v[120:123], v[40:47], v124
s_waitcnt lgkmcnt(6)
v_mfma_f32_32x32x16_bf16 v[96:111], v[48:51], v[176:179], v[96:111]
s_waitcnt vmcnt(0)
s_barrier
ds_read_b32 v88, v126
ds_read_b32 v84, v126 offset:512
v_add_u32 v116, -65536, v116
ds_read_b64_tr_b16 v[32:33], v116 offset:0
ds_read_b64_tr_b16 v[34:35], v116 offset:512
v_add_u32 v117, -65536, v117
ds_read_b64_tr_b16 v[36:37], v117 offset:0
ds_read_b64_tr_b16 v[38:39], v117 offset:512
s_waitcnt lgkmcnt(10)
v_mfma_f32_32x32x16_bf16 v[96:111], v[52:55], v[180:183], v[96:111]
v_smfmac_f32_16x16x64_bf16 v[76:79], v[120:123], v[48:55], v124
v_add_u32 v118, -65536, v118
ds_read_b64_tr_b16 v[40:41], v118 offset:0
ds_read_b64_tr_b16 v[42:43], v118 offset:512
v_add_u32 v119, -65536, v119
ds_read_b64_tr_b16 v[44:45], v119 offset:0
ds_read_b64_tr_b16 v[46:47], v119 offset:512
s_waitcnt lgkmcnt(12)
v_mfma_f32_32x32x16_bf16 v[96:111], v[56:59], v[184:187], v[96:111]
s_waitcnt lgkmcnt(10)
v_mfma_f32_32x32x16_bf16 v[96:111], v[60:63], v[188:191], v[96:111]
v_smfmac_f32_16x16x64_bf16 v[76:79], v[120:123], v[56:63], v124
ds_read_b64_tr_b16 v[48:49], v116 offset:8192
ds_read_b64_tr_b16 v[50:51], v116 offset:8704
ds_read_b64_tr_b16 v[52:53], v117 offset:8192
ds_read_b64_tr_b16 v[54:55], v117 offset:8704
s_waitcnt lgkmcnt(10)
v_mfma_f32_32x32x16_bf16 v[96:111], v[32:35], v[192:195], v[96:111]
s_waitcnt lgkmcnt(8)
v_mfma_f32_32x32x16_bf16 v[96:111], v[36:39], v[196:199], v[96:111]
v_smfmac_f32_16x16x64_bf16 v[76:79], v[120:123], v[32:39], v124
ds_read_b64_tr_b16 v[56:57], v118 offset:8192
ds_read_b64_tr_b16 v[58:59], v118 offset:8704
ds_read_b64_tr_b16 v[60:61], v119 offset:8192
ds_read_b64_tr_b16 v[62:63], v119 offset:8704
s_waitcnt lgkmcnt(10)
v_mfma_f32_32x32x16_bf16 v[96:111], v[40:43], v[200:203], v[96:111]
s_waitcnt lgkmcnt(8)
v_mfma_f32_32x32x16_bf16 v[96:111], v[44:47], v[204:207], v[96:111]
v_smfmac_f32_16x16x64_bf16 v[76:79], v[120:123], v[40:47], v124
ds_read_b64_tr_b16 v[32:33], v116 offset:16384
ds_read_b64_tr_b16 v[34:35], v116 offset:16896
ds_read_b64_tr_b16 v[36:37], v117 offset:16384
ds_read_b64_tr_b16 v[38:39], v117 offset:16896
s_waitcnt lgkmcnt(10)
v_mfma_f32_32x32x16_bf16 v[96:111], v[48:51], v[208:211], v[96:111]
s_waitcnt lgkmcnt(8)
v_mfma_f32_32x32x16_bf16 v[96:111], v[52:55], v[212:215], v[96:111]
v_smfmac_f32_16x16x64_bf16 v[76:79], v[120:123], v[48:55], v124
ds_read_b64_tr_b16 v[40:41], v118 offset:16384
ds_read_b64_tr_b16 v[42:43], v118 offset:16896
ds_read_b64_tr_b16 v[44:45], v119 offset:16384
ds_read_b64_tr_b16 v[46:47], v119 offset:16896
s_waitcnt lgkmcnt(10)
v_mfma_f32_32x32x16_bf16 v[96:111], v[56:59], v[216:219], v[96:111]
s_waitcnt lgkmcnt(8)
v_mfma_f32_32x32x16_bf16 v[96:111], v[60:63], v[220:223], v[96:111]
v_smfmac_f32_16x16x64_bf16 v[76:79], v[120:123], v[56:63], v124
ds_read_b64_tr_b16 v[48:49], v116 offset:24576
ds_read_b64_tr_b16 v[50:51], v116 offset:25088
ds_read_b64_tr_b16 v[52:53], v117 offset:24576
ds_read_b64_tr_b16 v[54:55], v117 offset:25088
s_barrier
s_waitcnt lgkmcnt(10)
v_mfma_f32_32x32x16_bf16 v[96:111], v[32:35], v[224:227], v[96:111]
s_waitcnt lgkmcnt(8)
v_mfma_f32_32x32x16_bf16 v[96:111], v[36:39], v[228:231], v[96:111]
v_smfmac_f32_16x16x64_bf16 v[76:79], v[120:123], v[32:39], v124
ds_read_b64_tr_b16 v[56:57], v118 offset:24576
ds_read_b64_tr_b16 v[58:59], v118 offset:25088
ds_read_b64_tr_b16 v[60:61], v119 offset:24576
ds_read_b64_tr_b16 v[62:63], v119 offset:25088
s_waitcnt lgkmcnt(10)
v_mfma_f32_32x32x16_bf16 v[96:111], v[40:43], v[232:235], v[96:111]
s_waitcnt lgkmcnt(8)
v_mfma_f32_32x32x16_bf16 v[96:111], v[44:47], v[236:239], v[96:111]
v_smfmac_f32_16x16x64_bf16 v[76:79], v[120:123], v[40:47], v124
s_waitcnt lgkmcnt(6)
v_mfma_f32_32x32x16_bf16 v[96:111], v[48:51], v[240:243], v[96:111]
s_waitcnt lgkmcnt(4)
v_mfma_f32_32x32x16_bf16 v[96:111], v[52:55], v[244:247], v[96:111]
v_smfmac_f32_16x16x64_bf16 v[76:79], v[120:123], v[48:55], v124
s_waitcnt lgkmcnt(0)
v_smfmac_f32_16x16x64_bf16 v[76:79], v[120:123], v[56:63], v124
s_waitcnt lgkmcnt(2)
v_mfma_f32_32x32x16_bf16 v[96:111], v[56:59], v[248:251], v[96:111]
s_nop 5
v_add_f32 v76, v76, v78
v_add_f32 v77, v77, v79
v_mul_f32 v88, 0x3eb8aa3b, v88
v_add_f32 v76, v76, v77
v_and_b32 v77, 0xffff0000, v76
v_sub_f32 v76, v76, v77
v_cvt_pk_bf16_f32 v80, v77, v76
s_waitcnt lgkmcnt(0)
v_mfma_f32_32x32x16_bf16 v[96:111], v[60:63], v[252:255], v[96:111]
v_mfma_f32_32x32x16_bf16 v[96:111], v[80:83], v[84:87], v[96:111]
s_nop 11
v_pk_mul_f32 v[96:97], v[96:97], v[88:89] op_sel_hi:[1,0]
v_pk_mul_f32 v[98:99], v[98:99], v[88:89] op_sel_hi:[1,0]
v_pk_mul_f32 v[100:101], v[100:101], v[88:89] op_sel_hi:[1,0]
v_pk_mul_f32 v[102:103], v[102:103], v[88:89] op_sel_hi:[1,0]
v_pk_mul_f32 v[104:105], v[104:105], v[88:89] op_sel_hi:[1,0]
v_pk_mul_f32 v[106:107], v[106:107], v[88:89] op_sel_hi:[1,0]
v_pk_mul_f32 v[108:109], v[108:109], v[88:89] op_sel_hi:[1,0]
v_pk_mul_f32 v[110:111], v[110:111], v[88:89] op_sel_hi:[1,0]
v_cvt_pk_bf16_f32 v32, v96, v97
v_cvt_pk_bf16_f32 v33, v98, v99
v_cvt_pk_bf16_f32 v34, v100, v101
v_cvt_pk_bf16_f32 v35, v102, v103
ds_write_b128 v125, v[32:35]
v_cvt_pk_bf16_f32 v36, v104, v105
v_cvt_pk_bf16_f32 v37, v106, v107
v_cvt_pk_bf16_f32 v38, v108, v109
v_cvt_pk_bf16_f32 v39, v110, v111
ds_write_b128 v125, v[36:39] offset:2048
s_waitcnt lgkmcnt(0)
s_setprio 0
s_barrier
s_barrier
buffer_load_dwordx4 v[64:67], v6, s[8:11], 0 offen
buffer_load_dwordx4 v[68:71], v6, s[8:11], 0 offen offset:16
global_load_dwordx4 v[24:27], v7, s[44:45]
global_load_dwordx4 v[28:31], v7, s[44:45] offset:16
global_load_dwordx4 v[20:23], v5, s[44:45]
buffer_load_dword v19, v19, s[16:19], s100 offen sc1
s_add_u32 s62, s58, 0
s_and_b32 s62, s62, 7
s_lshl_b32 s62, s62, 14
s_add_u32 s61, s62, s57
s_add_u32 m0, s60, 0
s_nop 0
buffer_load_dwordx4 v4, s[20:23], s61 offen lds
s_add_u32 s61, s61, 4096
s_add_u32 m0, s60, 1024
s_nop 0
buffer_load_dwordx4 v4, s[20:23], s61 offen lds
s_add_u32 s61, s61, 4096
s_add_u32 m0, s60, 2048
s_nop 0
buffer_load_dwordx4 v4, s[20:23], s61 offen lds
s_add_u32 s61, s61, 4096
s_add_u32 m0, s60, 3072
s_nop 0
buffer_load_dwordx4 v4, s[20:23], s61 offen lds
s_add_u32 s62, s58, 1
s_and_b32 s62, s62, 7
s_lshl_b32 s62, s62, 14
s_add_u32 s61, s62, s57
s_add_u32 m0, s60, 4096
s_nop 0
buffer_load_dwordx4 v4, s[20:23], s61 offen lds
s_add_u32 s61, s61, 4096
s_add_u32 m0, s60, 5120
s_nop 0
buffer_load_dwordx4 v4, s[20:23], s61 offen lds
s_add_u32 s61, s61, 4096
s_add_u32 m0, s60, 6144
s_nop 0
buffer_load_dwordx4 v4, s[20:23], s61 offen lds
s_add_u32 s61, s61, 4096
s_add_u32 m0, s60, 7168
s_nop 0
buffer_load_dwordx4 v4, s[20:23], s61 offen lds
s_add_u32 s62, s58, 2
s_and_b32 s62, s62, 7
s_lshl_b32 s62, s62, 14
s_add_u32 s61, s62, s57
s_add_u32 m0, s60, 8192
s_nop 0
buffer_load_dwordx4 v4, s[20:23], s61 offen lds
s_add_u32 s61, s61, 4096
s_add_u32 m0, s60, 9216
s_nop 0
buffer_load_dwordx4 v4, s[20:23], s61 offen lds
s_add_u32 s61, s61, 4096
s_add_u32 m0, s60, 10240
s_nop 0
buffer_load_dwordx4 v4, s[20:23], s61 offen lds
s_add_u32 s61, s61, 4096
s_add_u32 m0, s60, 11264
s_nop 0
buffer_load_dwordx4 v4, s[20:23], s61 offen lds
s_add_u32 s62, s58, 3
s_and_b32 s62, s62, 7
s_lshl_b32 s62, s62, 14
s_add_u32 s61, s62, s57
s_add_u32 m0, s60, 12288
s_nop 0
buffer_load_dwordx4 v4, s[20:23], s61 offen lds
s_add_u32 s61, s61, 4096
s_add_u32 m0, s60, 13312
s_nop 0
buffer_load_dwordx4 v4, s[20:23], s61 offen lds
s_add_u32 s61, s61, 4096
s_add_u32 m0, s60, 14336
s_nop 0
buffer_load_dwordx4 v4, s[20:23], s61 offen lds
s_add_u32 s61, s61, 4096
s_add_u32 m0, s60, 15360
s_nop 0
buffer_load_dwordx4 v4, s[20:23], s61 offen lds
s_bitcmp1_b32 s3, 1
s_cselect_b32 s62, 1, -1
s_lshl_b32 s62, s62, 15
s_add_u32 s60, s60, s62
s_lshl_b32 s62, s62, 2
s_add_u32 s57, s57, s62
s_add_u32 s62, s58, 0
s_and_b32 s62, s62, 7
s_lshl_b32 s62, s62, 14
s_add_u32 s61, s62, s57
s_add_u32 m0, s60, 0
s_nop 0
buffer_load_dwordx4 v4, s[20:23], s61 offen lds
s_add_u32 s61, s61, 4096
s_add_u32 m0, s60, 1024
s_nop 0
buffer_load_dwordx4 v4, s[20:23], s61 offen lds
s_add_u32 s61, s61, 4096
s_add_u32 m0, s60, 2048
s_nop 0
buffer_load_dwordx4 v4, s[20:23], s61 offen lds
s_add_u32 s61, s61, 4096
s_add_u32 m0, s60, 3072
s_nop 0
buffer_load_dwordx4 v4, s[20:23], s61 offen lds
s_add_u32 s62, s58, 1
s_and_b32 s62, s62, 7
s_lshl_b32 s62, s62, 14
s_add_u32 s61, s62, s57
s_add_u32 m0, s60, 4096
s_nop 0
buffer_load_dwordx4 v4, s[20:23], s61 offen lds
s_add_u32 s61, s61, 4096
s_add_u32 m0, s60, 5120
s_nop 0
buffer_load_dwordx4 v4, s[20:23], s61 offen lds
s_add_u32 s61, s61, 4096
s_add_u32 m0, s60, 6144
s_nop 0
buffer_load_dwordx4 v4, s[20:23], s61 offen lds
s_add_u32 s61, s61, 4096
s_add_u32 m0, s60, 7168
s_nop 0
buffer_load_dwordx4 v4, s[20:23], s61 offen lds
s_add_u32 s62, s58, 2
s_and_b32 s62, s62, 7
s_lshl_b32 s62, s62, 14
s_add_u32 s61, s62, s57
s_add_u32 m0, s60, 8192
s_nop 0
buffer_load_dwordx4 v4, s[20:23], s61 offen lds
s_add_u32 s61, s61, 4096
s_add_u32 m0, s60, 9216
s_nop 0
buffer_load_dwordx4 v4, s[20:23], s61 offen lds
s_add_u32 s61, s61, 4096
s_add_u32 m0, s60, 10240
s_nop 0
buffer_load_dwordx4 v4, s[20:23], s61 offen lds
s_add_u32 s61, s61, 4096
s_add_u32 m0, s60, 11264
s_nop 0
buffer_load_dwordx4 v4, s[20:23], s61 offen lds
s_add_u32 s62, s58, 3
s_and_b32 s62, s62, 7
s_lshl_b32 s62, s62, 14
s_add_u32 s61, s62, s57
s_add_u32 m0, s60, 12288
s_nop 0
buffer_load_dwordx4 v4, s[20:23], s61 offen lds
s_add_u32 s61, s61, 4096
s_add_u32 m0, s60, 13312
s_nop 0
buffer_load_dwordx4 v4, s[20:23], s61 offen lds
s_add_u32 s61, s61, 4096
s_add_u32 m0, s60, 14336
s_nop 0
buffer_load_dwordx4 v4, s[20:23], s61 offen lds
s_add_u32 s61, s61, 4096
s_add_u32 m0, s60, 15360
s_nop 0
buffer_load_dwordx4 v4, s[20:23], s61 offen lds
s_add_u32 s62, s65, 0
s_and_b32 s62, s62, 7
s_mul_i32 s8, s62, 1280
s_add_u32 s62, s65, 1
s_and_b32 s62, s62, 7
s_mul_i32 s9, s62, 1280
s_add_u32 s62, s65, 2
s_and_b32 s62, s62, 7
s_mul_i32 s10, s62, 1280
s_add_u32 s62, s65, 3
s_and_b32 s62, s62, 7
s_mul_i32 s11, s62, 1280
s_add_u32 s62, s65, 4
s_and_b32 s62, s62, 7
s_mul_i32 s12, s62, 1280
s_add_u32 s62, s65, 5
s_and_b32 s62, s62, 7
s_mul_i32 s13, s62, 1280
s_add_u32 s62, s65, 6
s_and_b32 s62, s62, 7
s_mul_i32 s14, s62, 1280
s_add_u32 s62, s65, 7
s_and_b32 s62, s62, 7
s_mul_i32 s15, s62, 1280
s_lshl_b32 s62, s59, 13
s_lshl_b32 s63, s3, 11
s_add_u32 s62, s62, s63
s_add_u32 m0, s63, 155648
s_nop 0
buffer_load_dwordx4 v5, s[32:35], s62 offen lds
buffer_load_dwordx4 v5, s[32:35], s62 offen offset:1024 lds
s_waitcnt vmcnt(35)
v_lshlrev_b32 v80, 16, v64
v_and_b32 v81, 0xffff0000, v64
v_lshlrev_b32 v82, 16, v65
v_and_b32 v83, 0xffff0000, v65
v_lshlrev_b32 v84, 16, v66
v_and_b32 v85, 0xffff0000, v66
v_lshlrev_b32 v86, 16, v67
v_and_b32 v87, 0xffff0000, v67
v_lshlrev_b32 v88, 16, v68
v_and_b32 v89, 0xffff0000, v68
v_lshlrev_b32 v90, 16, v69
v_and_b32 v91, 0xffff0000, v69
v_lshlrev_b32 v92, 16, v70
v_and_b32 v93, 0xffff0000, v70
v_lshlrev_b32 v94, 16, v71
v_and_b32 v95, 0xffff0000, v71
v_mov_b32 v17, 0
v_dot2c_f32_bf16 v17, s64, v20
v_dot2c_f32_bf16 v17, s64, v21
v_dot2c_f32_bf16 v17, s64, v22
v_dot2c_f32_bf16 v17, s64, v23
s_nop 2
v_add_f32_dpp v17, v17, v17 row_ror:8 row_mask:0xf bank_mask:0xf
s_nop 1
v_add_f32_dpp v17, v17, v17 row_ror:4 row_mask:0xf bank_mask:0xf
s_nop 1
v_add_f32_dpp v17, v17, v17 row_ror:2 row_mask:0xf bank_mask:0xf
s_nop 1
v_add_f32_dpp v17, v17, v17 row_ror:1 row_mask:0xf bank_mask:0xf
s_nop 0
v_readlane_b32 s67, v17, 0
v_readlane_b32 s68, v17, 16
v_readlane_b32 s69, v17, 32
v_readlane_b32 s70, v17, 48
v_mov_b32 v17, s67
v_add_f32 v17, s68, v17
v_add_f32 v17, s69, v17
v_add_f32 v17, s70, v17
s_lshl_b32 s62, s3, 10
s_add_u32 s62, s62, 147456
v_add_u32 v13, s62, v5
v_and_b32 v14, 31, v0
v_lshrrev_b32 v15, 5, v0
v_lshlrev_b32 v14, 4, v14
v_lshl_add_u32 v14, v15, 10, v14
v_mov_b32 v20, 0
v_mov_b32 v21, 0
v_mov_b32 v22, 0
v_mov_b32 v23, s6
s_lshl_b32 s57, s65, 2
s_add_u32 s57, s57, s3
s_mul_i32 s57, s57, 10240
s_add_u32 s57, s57, 5767168
s_lshl_b32 s67, s6, 3
s_add_u32 s8, s8, s57
s_add_u32 s9, s9, s57
s_add_u32 s10, s10, s57
s_add_u32 s11, s11, s57
s_add_u32 s12, s12, s57
s_add_u32 s13, s13, s57
s_add_u32 s14, s14, s57
s_add_u32 s15, s15, s57
s_waitcnt vmcnt(2)
s_barrier
ds_read_b64_tr_b16 v[128:129], v8 offset:0
ds_read_b64_tr_b16 v[130:131], v8 offset:2048
ds_read_b64_tr_b16 v[132:133], v8 offset:4096
ds_read_b64_tr_b16 v[134:135], v8 offset:6144
ds_read_b64_tr_b16 v[136:137], v8 offset:8192
ds_read_b64_tr_b16 v[138:139], v8 offset:10240
ds_read_b64_tr_b16 v[140:141], v8 offset:12288
ds_read_b64_tr_b16 v[142:143], v8 offset:14336
ds_read_b64_tr_b16 v[144:145], v8 offset:16384
ds_read_b64_tr_b16 v[146:147], v8 offset:18432
ds_read_b64_tr_b16 v[148:149], v8 offset:20480
ds_read_b64_tr_b16 v[150:151], v8 offset:22528
ds_read_b64_tr_b16 v[152:153], v8 offset:24576
ds_read_b64_tr_b16 v[154:155], v8 offset:26624
ds_read_b64_tr_b16 v[156:157], v8 offset:28672
ds_read_b64_tr_b16 v[158:159], v8 offset:30720
ds_read_b64_tr_b16 v[160:161], v9 offset:0
ds_read_b64_tr_b16 v[162:163], v9 offset:2048
ds_read_b64_tr_b16 v[164:165], v9 offset:4096
ds_read_b64_tr_b16 v[166:167], v9 offset:6144
ds_read_b64_tr_b16 v[168:169], v9 offset:8192
ds_read_b64_tr_b16 v[170:171], v9 offset:10240
ds_read_b64_tr_b16 v[172:173], v9 offset:12288
ds_read_b64_tr_b16 v[174:175], v9 offset:14336
ds_read_b64_tr_b16 v[176:177], v9 offset:16384
ds_read_b64_tr_b16 v[178:179], v9 offset:18432
ds_read_b64_tr_b16 v[180:181], v9 offset:20480
ds_read_b64_tr_b16 v[182:183], v9 offset:22528
ds_read_b64_tr_b16 v[184:185], v9 offset:24576
ds_read_b64_tr_b16 v[186:187], v9 offset:26624
ds_read_b64_tr_b16 v[188:189], v9 offset:28672
ds_read_b64_tr_b16 v[190:191], v9 offset:30720
ds_read_b64_tr_b16 v[192:193], v10 offset:0
ds_read_b64_tr_b16 v[194:195], v10 offset:2048
ds_read_b64_tr_b16 v[196:197], v10 offset:4096
ds_read_b64_tr_b16 v[198:199], v10 offset:6144
ds_read_b64_tr_b16 v[200:201], v10 offset:8192
ds_read_b64_tr_b16 v[202:203], v10 offset:10240
ds_read_b64_tr_b16 v[204:205], v10 offset:12288
ds_read_b64_tr_b16 v[206:207], v10 offset:14336
ds_read_b64_tr_b16 v[208:209], v10 offset:16384
ds_read_b64_tr_b16 v[210:211], v10 offset:18432
ds_read_b64_tr_b16 v[212:213], v10 offset:20480
ds_read_b64_tr_b16 v[214:215], v10 offset:22528
ds_read_b64_tr_b16 v[216:217], v10 offset:24576
ds_read_b64_tr_b16 v[218:219], v10 offset:26624
ds_read_b64_tr_b16 v[220:221], v10 offset:28672
ds_read_b64_tr_b16 v[222:223], v10 offset:30720
ds_read_b64_tr_b16 v[224:225], v11 offset:0
ds_read_b64_tr_b16 v[226:227], v11 offset:2048
ds_read_b64_tr_b16 v[228:229], v11 offset:4096
ds_read_b64_tr_b16 v[230:231], v11 offset:6144
ds_read_b64_tr_b16 v[232:233], v11 offset:8192
ds_read_b64_tr_b16 v[234:235], v11 offset:10240
ds_read_b64_tr_b16 v[236:237], v11 offset:12288
ds_read_b64_tr_b16 v[238:239], v11 offset:14336
ds_read_b64_tr_b16 v[240:241], v11 offset:16384
ds_read_b64_tr_b16 v[242:243], v11 offset:18432
ds_read_b64_tr_b16 v[244:245], v11 offset:20480
ds_read_b64_tr_b16 v[246:247], v11 offset:22528
ds_read_b64_tr_b16 v[248:249], v11 offset:24576
ds_read_b64_tr_b16 v[250:251], v11 offset:26624
ds_read_b64_tr_b16 v[252:253], v11 offset:28672
ds_read_b64_tr_b16 v[254:255], v11 offset:30720
s_lshr_b32 s62, s3, 1
s_add_u32 s62, s62, s59
s_add_u32 s62, s62, 0
s_and_b32 s62, s62, 7
s_lshr_b32 s63, s62, 1
s_lshl_b32 s63, s63, 2
s_and_b32 s70, s62, 1
s_add_u32 s63, s63, s70
s_and_b32 s70, s3, 1
s_lshl_b32 s70, s70, 1
s_add_u32 s63, s63, s70
s_lshl_b32 s63, s63, 10
s_add_u32 s96, s63, 131072
s_mul_i32 s62, s62, 229376
s_lshl_b32 s63, s59, 4
s_add_u32 s62, s62, s63
s_cmp_ge_u32 s59, 224
s_cselect_b32 s97, 0x7f000000, s62
s_lshr_b32 s62, s3, 1
s_add_u32 s62, s62, s59
s_add_u32 s62, s62, 2
s_and_b32 s62, s62, 7
s_lshr_b32 s63, s62, 1
s_lshl_b32 s63, s63, 2
s_and_b32 s70, s62, 1
s_add_u32 s63, s63, s70
s_and_b32 s70, s3, 1
s_lshl_b32 s70, s70, 1
s_add_u32 s63, s63, s70
s_lshl_b32 s63, s63, 10
s_add_u32 s98, s63, 131072
s_mul_i32 s62, s62, 229376
s_lshl_b32 s63, s59, 4
s_add_u32 s62, s62, s63
s_cmp_ge_u32 s59, 224
s_cselect_b32 s99, 0x7f000000, s62
buffer_load_dwordx4 v[96:99], v5, s[16:19], s8 offen sc1
buffer_load_dword v32, v3, s[16:19], s8 offen sc1
buffer_load_dwordx4 v[100:103], v5, s[16:19], s9 offen sc1
buffer_load_dword v33, v3, s[16:19], s9 offen sc1
buffer_load_dwordx4 v[104:107], v5, s[16:19], s10 offen sc1
buffer_load_dword v34, v3, s[16:19], s10 offen sc1
buffer_load_dwordx4 v[108:111], v5, s[16:19], s11 offen sc1
buffer_load_dword v35, v3, s[16:19], s11 offen sc1
buffer_load_dwordx4 v[112:115], v5, s[16:19], s12 offen sc1
buffer_load_dword v36, v3, s[16:19], s12 offen sc1
buffer_load_dwordx4 v[116:119], v5, s[16:19], s13 offen sc1
buffer_load_dword v37, v3, s[16:19], s13 offen sc1
buffer_load_dwordx4 v[120:123], v5, s[16:19], s14 offen sc1
buffer_load_dword v38, v3, s[16:19], s14 offen sc1
buffer_load_dwordx4 v[124:127], v5, s[16:19], s15 offen sc1
buffer_load_dword v39, v3, s[16:19], s15 offen sc1
s_waitcnt lgkmcnt(0)
s_barrier
s_waitcnt vmcnt(15)
ds_write_b128 v72, v[96:99] offset:0
s_waitcnt vmcnt(13)
ds_write_b128 v72, v[100:103] offset:1024
s_waitcnt vmcnt(11)
ds_write_b128 v72, v[104:107] offset:2048
s_waitcnt vmcnt(9)
ds_write_b128 v72, v[108:111] offset:3072
s_waitcnt vmcnt(7)
ds_write_b128 v72, v[112:115] offset:4096
s_waitcnt vmcnt(5)
ds_write_b128 v72, v[116:119] offset:5120
s_waitcnt vmcnt(3)
ds_write_b128 v72, v[120:123] offset:6144
s_waitcnt vmcnt(1)
ds_write_b128 v72, v[124:127] offset:7168
s_waitcnt vmcnt(0)
v_add3_u32 v40, s67, v96, v97
v_add3_u32 v41, v112, v113, v114
v_add3_u32 v42, v32, v33, v34
v_add3_u32 v40, v40, v98, v99
v_add3_u32 v41, v41, v115, v116
v_add3_u32 v42, v42, v35, v36
v_add3_u32 v40, v40, v100, v101
v_add3_u32 v41, v41, v117, v118
v_add3_u32 v42, v42, v37, v38
v_add3_u32 v40, v40, v102, v103
v_add3_u32 v41, v41, v119, v120
v_add_u32 v42, v42, v39
v_add3_u32 v40, v40, v104, v105
v_add3_u32 v41, v41, v121, v122
v_add3_u32 v40, v40, v106, v107
v_add3_u32 v41, v41, v123, v124
v_add3_u32 v40, v40, v108, v109
v_add3_u32 v41, v41, v125, v126
v_add3_u32 v40, v40, v110, v111
v_add_u32 v41, v41, v127
v_add_u32 v40, v40, v41
v_cmp_ne_u32 vcc, v40, v42
s_cbranch_vccnz L_oretry
L_ook:
v_mfma_f32_32x32x16_bf16 v[80:95], v[128:131], v[96:99], v[80:95]
v_mfma_f32_32x32x16_bf16 v[80:95], v[132:135], v[100:103], v[80:95]
v_mfma_f32_32x32x16_bf16 v[80:95], v[136:139], v[104:107], v[80:95]
v_mfma_f32_32x32x16_bf16 v[80:95], v[140:143], v[108:111], v[80:95]
s_waitcnt lgkmcnt(0)
s_barrier
s_mov_b32 m0, s96
s_nop 0
buffer_load_dwordx4 v18, s[28:31], s97 offen lds
s_mov_b32 m0, s98
s_nop 0
buffer_load_dwordx4 v18, s[28:31], s99 offen lds
ds_read_b128 v[32:35], v73 offset:0
ds_read_b128 v[36:39], v73 offset:1024
ds_read_b128 v[40:43], v73 offset:2048
ds_read_b128 v[44:47], v73 offset:3072
ds_read_b128 v[48:51], v73 offset:4096
ds_read_b128 v[52:55], v73 offset:5120
ds_read_b128 v[56:59], v73 offset:6144
ds_read_b128 v[60:63], v73 offset:7168
v_mfma_f32_32x32x16_bf16 v[80:95], v[144:147], v[112:115], v[80:95]
ds_read_b128 v[96:99], v74 offset:0
v_mfma_f32_32x32x16_bf16 v[80:95], v[148:151], v[116:119], v[80:95]
ds_read_b128 v[100:103], v74 offset:1024
v_mfma_f32_32x32x16_bf16 v[80:95], v[152:155], v[120:123], v[80:95]
ds_read_b128 v[104:107], v74 offset:2048
v_mfma_f32_32x32x16_bf16 v[80:95], v[156:159], v[124:127], v[80:95]
ds_read_b128 v[108:111], v74 offset:3072
s_waitcnt lgkmcnt(11)
v_mfma_f32_32x32x16_bf16 v[80:95], v[160:163], v[32:35], v[80:95]
ds_read_b128 v[112:115], v74 offset:4096
s_waitcnt lgkmcnt(11)
v_mfma_f32_32x32x16_bf16 v[80:95], v[164:167], v[36:39], v[80:95]
ds_read_b128 v[116:119], v74 offset:5120
s_waitcnt lgkmcnt(11)
v_mfma_f32_32x32x16_bf16 v[80:95], v[168:171], v[40:43], v[80:95]
ds_read_b128 v[120:123], v74 offset:6144
s_waitcnt lgkmcnt(11)
v_mfma_f32_32x32x16_bf16 v[80:95], v[172:175], v[44:47], v[80:95]
ds_read_b128 v[124:127], v74 offset:7168
s_waitcnt lgkmcnt(11)
v_mfma_f32_32x32x16_bf16 v[80:95], v[176:179], v[48:51], v[80:95]
ds_read_b128 v[32:35], v75 offset:0
s_waitcnt lgkmcnt(11)
v_mfma_f32_32x32x16_bf16 v[80:95], v[180:183], v[52:55], v[80:95]
ds_read_b128 v[36:39], v75 offset:1024
s_waitcnt lgkmcnt(11)
v_mfma_f32_32x32x16_bf16 v[80:95], v[184:187], v[56:59], v[80:95]
ds_read_b128 v[40:43], v75 offset:2048
s_waitcnt lgkmcnt(11)
v_mfma_f32_32x32x16_bf16 v[80:95], v[188:191], v[60:63], v[80:95]
ds_read_b128 v[44:47], v75 offset:3072
s_waitcnt lgkmcnt(11)
v_mfma_f32_32x32x16_bf16 v[80:95], v[192:195], v[96:99], v[80:95]
ds_read_b128 v[48:51], v75 offset:4096
s_waitcnt lgkmcnt(11)
v_mfma_f32_32x32x16_bf16 v[80:95], v[196:199], v[100:103], v[80:95]
ds_read_b128 v[52:55], v75 offset:5120
s_waitcnt lgkmcnt(11)
v_mfma_f32_32x32x16_bf16 v[80:95], v[200:203], v[104:107], v[80:95]
ds_read_b128 v[56:59], v75 offset:6144
s_waitcnt lgkmcnt(11)
v_mfma_f32_32x32x16_bf16 v[80:95], v[204:207], v[108:111], v[80:95]
ds_read_b128 v[60:63], v75 offset:7168
s_waitcnt lgkmcnt(11)
v_mfma_f32_32x32x16_bf16 v[80:95], v[208:211], v[112:115], v[80:95]
s_waitcnt lgkmcnt(10)
v_mfma_f32_32x32x16_bf16 v[80:95], v[212:215], v[116:119], v[80:95]
s_waitcnt lgkmcnt(9)
v_mfma_f32_32x32x16_bf16 v[80:95], v[216:219], v[120:123], v[80:95]
s_waitcnt lgkmcnt(8)
v_mfma_f32_32x32x16_bf16 v[80:95], v[220:223], v[124:127], v[80:95]
s_waitcnt lgkmcnt(7)
v_mfma_f32_32x32x16_bf16 v[80:95], v[224:227], v[32:35], v[80:95]
s_waitcnt lgkmcnt(6)
v_mfma_f32_32x32x16_bf16 v[80:95], v[228:231], v[36:39], v[80:95]
s_waitcnt lgkmcnt(5)
v_mfma_f32_32x32x16_bf16 v[80:95], v[232:235], v[40:43], v[80:95]
s_waitcnt lgkmcnt(4)
v_mfma_f32_32x32x16_bf16 v[80:95], v[236:239], v[44:47], v[80:95]
s_waitcnt lgkmcnt(3)
v_mfma_f32_32x32x16_bf16 v[80:95], v[240:243], v[48:51], v[80:95]
s_waitcnt lgkmcnt(2)
v_mfma_f32_32x32x16_bf16 v[80:95], v[244:247], v[52:55], v[80:95]
s_waitcnt lgkmcnt(1)
v_mfma_f32_32x32x16_bf16 v[80:95], v[248:251], v[56:59], v[80:95]
s_waitcnt lgkmcnt(0)
v_mfma_f32_32x32x16_bf16 v[80:95], v[252:255], v[60:63], v[80:95]
s_nop 11
v_cvt_pk_bf16_f32 v64, v80, v81
v_cvt_pk_bf16_f32 v65, v82, v83
v_cvt_pk_bf16_f32 v66, v84, v85
v_cvt_pk_bf16_f32 v67, v86, v87
v_cvt_pk_bf16_f32 v68, v88, v89
v_cvt_pk_bf16_f32 v69, v90, v91
v_cvt_pk_bf16_f32 v70, v92, v93
v_cvt_pk_bf16_f32 v71, v94, v95
v_dot2c_f32_bf16 v20, s64, v64
v_dot2c_f32_bf16 v21, v64, v64
v_dot2c_f32_bf16 v22, v24, v64
v_dot2c_f32_bf16 v20, s64, v65
v_dot2c_f32_bf16 v21, v65, v65
v_dot2c_f32_bf16 v22, v25, v65
v_dot2c_f32_bf16 v20, s64, v66
v_dot2c_f32_bf16 v21, v66, v66
v_dot2c_f32_bf16 v22, v26, v66
v_dot2c_f32_bf16 v20, s64, v67
v_dot2c_f32_bf16 v21, v67, v67
v_dot2c_f32_bf16 v22, v27, v67
v_dot2c_f32_bf16 v20, s64, v68
v_dot2c_f32_bf16 v21, v68, v68
v_dot2c_f32_bf16 v22, v28, v68
v_dot2c_f32_bf16 v20, s64, v69
v_dot2c_f32_bf16 v21, v69, v69
v_dot2c_f32_bf16 v22, v29, v69
v_dot2c_f32_bf16 v20, s64, v70
v_dot2c_f32_bf16 v21, v70, v70
v_dot2c_f32_bf16 v22, v30, v70
v_dot2c_f32_bf16 v20, s64, v71
v_dot2c_f32_bf16 v21, v71, v71
v_dot2c_f32_bf16 v22, v31, v71
s_nop 2
ds_write_b128 v13, v[20:23]
s_waitcnt lgkmcnt(0)
s_barrier
s_lshl_b32 s57, s65, 11
s_add_u32 s57, s57, 8192
s_cmp_lg_u32 s3, 0
s_cbranch_scc1 L_nopub
ds_read_b128 v[32:35], v13 offset:1024
ds_read_b128 v[36:39], v13 offset:2048
ds_read_b128 v[40:43], v13 offset:3072
s_lshl_b32 s58, s66, 9
s_add_u32 s58, s58, s57
s_waitcnt lgkmcnt(1)
v_pk_add_f32 v[32:33], v[32:33], v[36:37]
v_add_f32 v34, v34, v38
s_waitcnt lgkmcnt(0)
v_pk_add_f32 v[20:21], v[20:21], v[40:41]
v_add_f32 v22, v22, v42
v_pk_add_f32 v[20:21], v[20:21], v[32:33]
v_add_f32 v22, v22, v34
v_mov_b32 v32, v20
v_mov_b32 v33, v21
v_mov_b32 v34, v22
v_permlane32_swap_b32 v20, v32
v_permlane32_swap_b32 v21, v33
v_permlane32_swap_b32 v22, v34
v_pk_add_f32 v[20:21], v[20:21], v[32:33]
v_add_f32 v22, v22, v34
s_mov_b64 exec, 0xffffffff
buffer_store_dwordx4 v[20:23], v5, s[16:19], s58 offen
s_mov_b64 exec, -1
L_nopub:
v_lshlrev_b32 v80, 16, v64
v_and_b32 v81, 0xffff0000, v64
v_lshlrev_b32 v82, 16, v65
v_and_b32 v83, 0xffff0000, v65
v_lshlrev_b32 v84, 16, v66
v_and_b32 v85, 0xffff0000, v66
v_lshlrev_b32 v86, 16, v67
v_and_b32 v87, 0xffff0000, v67
v_lshlrev_b32 v88, 16, v68
v_and_b32 v89, 0xffff0000, v68
v_lshlrev_b32 v90, 16, v69
v_and_b32 v91, 0xffff0000, v69
v_lshlrev_b32 v92, 16, v70
v_and_b32 v93, 0xffff0000, v70
v_lshlrev_b32 v94, 16, v71
v_and_b32 v95, 0xffff0000, v71
v_add3_u32 v57, s6, v64, v65
v_add3_u32 v57, v57, v66, v67
v_add3_u32 v57, v57, v68, v69
v_add3_u32 v57, v57, v70, v71
v_lshlrev_b32 v12, 2, v7
v_lshlrev_b32 v15, 13, v0
s_lshl_b32 s60, s65, 12
s_add_u32 s60, s60, 262144
s_lshl_b32 s61, s65, 4
s_add_u32 s61, s61, 196608
s_or_b32 s62, s3, s66
s_sleep 2
s_movk_i32 s71, 20000
poll_1:
buffer_load_dwordx4 v[32:35], v14, s[16:19], s57 offen sc1
buffer_load_dwordx4 v[36:39], v14, s[16:19], s57 offen offset:512 sc1
s_waitcnt vmcnt(0)
v_bitop3_b32 v35, v35, v39, s6 bitop3:0x7e
v_cmp_ne_u32 vcc, 0, v35
s_cbranch_vccz polld_2
s_sub_u32 s71, s71, 1
s_cbranch_scc1 polld_2
s_and_b32 vcc_lo, s71, 31
s_cbranch_scc1 poll_1
buffer_wbl2 sc1
s_branch poll_1
polld_2:
v_pk_add_f32 v[20:21], v[32:33], v[36:37]
v_add_f32 v22, v34, v38
v_mov_b32 v32, v20
v_mov_b32 v33, v21
v_mov_b32 v34, v22
v_permlane32_swap_b32 v20, v32
v_permlane32_swap_b32 v21, v33
v_permlane32_swap_b32 v22, v34
v_pk_add_f32 v[20:21], v[20:21], v[32:33]
v_add_f32 v22, v22, v34
v_mul_f32 v26, 0x3b000000, v20
v_mul_f32 v21, 0x3b000000, v21
v_fma_f32 v21, -v26, v26, v21
v_max_f32 v21, 0, v21
v_cvt_pk_bf16_f32 v25, v26, v21
v_and_b32 v21, 0xffff0000, v25
v_add_f32 v21, 0x3727c5ac, v21
v_lshlrev_b32 v26, 16, v25
v_cvt_pk_bf16_f32 v21, v21, v21
v_and_b32 v21, 0xffff0000, v21
v_sqrt_f32 v21, v21
s_nop 0
v_cvt_pk_bf16_f32 v21, v21, v21
v_and_b32 v21, 0xffff0000, v21
v_rcp_f32 v28, v21
v_fma_f32 v22, -v26, v17, v22
v_mul_f32 v22, v22, v28
v_mul_f32 v30, v26, v28
v_ashrrev_i32 v25, 31, v22
v_or_b32 v25, 0x80000000, v25
v_xor_b32 v22, v22, v25
v_and_b32 v22, 0xfffff800, v22
v_or_b32 v22, v22, v16
v_pk_fma_f32 v[32:33], v[80:81], v[28:29], v[30:31] op_sel_hi:[1,0,0] neg_lo:[0,0,1] neg_hi:[0,0,1]
v_pk_fma_f32 v[34:35], v[82:83], v[28:29], v[30:31] op_sel_hi:[1,0,0] neg_lo:[0,0,1] neg_hi:[0,0,1]
v_max_u32_dpp v22, v22, v22 row_ror:8 row_mask:0xf bank_mask:0xf
v_pk_fma_f32 v[36:37], v[84:85], v[28:29], v[30:31] op_sel_hi:[1,0,0] neg_lo:[0,0,1] neg_hi:[0,0,1]
v_pk_fma_f32 v[38:39], v[86:87], v[28:29], v[30:31] op_sel_hi:[1,0,0] neg_lo:[0,0,1] neg_hi:[0,0,1]
v_max_u32_dpp v22, v22, v22 row_ror:4 row_mask:0xf bank_mask:0xf
v_pk_fma_f32 v[40:41], v[88:89], v[28:29], v[30:31] op_sel_hi:[1,0,0] neg_lo:[0,0,1] neg_hi:[0,0,1]
v_pk_fma_f32 v[42:43], v[90:91], v[28:29], v[30:31] op_sel_hi:[1,0,0] neg_lo:[0,0,1] neg_hi:[0,0,1]
v_max_u32_dpp v22, v22, v22 row_ror:2 row_mask:0xf bank_mask:0xf
v_pk_fma_f32 v[44:45], v[92:93], v[28:29], v[30:31] op_sel_hi:[1,0,0] neg_lo:[0,0,1] neg_hi:[0,0,1]
v_pk_fma_f32 v[46:47], v[94:95], v[28:29], v[30:31] op_sel_hi:[1,0,0] neg_lo:[0,0,1] neg_hi:[0,0,1]
v_max_u32_dpp v22, v22, v22 row_ror:1 row_mask:0xf bank_mask:0xf
v_cvt_pk_bf16_f32 v48, v32, v33
v_readlane_b32 s67, v22, 0
v_readlane_b32 s68, v22, 16
v_cvt_pk_bf16_f32 v49, v34, v35
s_max_u32 s67, s67, s68
s_cmp_lg_u32 s62, 0
s_cbranch_scc1 L_nocand
v_mov_b32 v22, s67
s_mov_b64 exec, 255
buffer_store_dwordx2 v[22:23], v15, s[16:19], s61 offen sc1
s_mov_b64 exec, -1
L_nocand:
s_andn2_b32 s68, 31, s67
s_mov_b32 s96, 1
s_mov_b32 s97, 1
s_lshl_b64 s[96:97], s[96:97], s68
v_cvt_pk_bf16_f32 v50, v36, v37
v_cvt_pk_bf16_f32 v51, v38, v39
v_cvt_pk_bf16_f32 v52, v40, v41
v_cvt_pk_bf16_f32 v53, v42, v43
v_cvt_pk_bf16_f32 v54, v44, v45
v_cvt_pk_bf16_f32 v55, v46, v47
v_add3_u32 v56, s6, v48, v49
v_add3_u32 v56, v56, v50, v51
v_add3_u32 v56, v56, v52, v53
v_add3_u32 v56, v56, v54, v55
s_mov_b64 exec, s[96:97]
buffer_store_dwordx4 v[48:51], v12, s[16:19], s60 offen sc1
buffer_store_dwordx4 v[52:55], v12, s[16:19], s60 offen offset:16 sc1
buffer_store_dwordx2 v[56:57], v12, s[16:19], s60 offen offset:32 sc1
buffer_store_dwordx4 v[64:67], v12, s[16:19], s60 offen offset:48 sc1
buffer_store_dwordx4 v[68:71], v12, s[16:19], s60 offen offset:64 sc1
s_mov_b64 exec, -1
s_barrier
s_lshr_b32 s62, s3, 1
s_add_u32 s62, s62, s59
s_add_u32 s62, s62, 4
s_and_b32 s62, s62, 7
s_lshr_b32 s63, s62, 1
s_lshl_b32 s63, s63, 2
s_and_b32 s70, s62, 1
s_add_u32 s63, s63, s70
s_and_b32 s70, s3, 1
s_lshl_b32 s70, s70, 1
s_add_u32 s63, s63, s70
s_lshl_b32 s63, s63, 10
s_add_u32 m0, s63, 131072
s_mul_i32 s62, s62, 229376
s_lshl_b32 s63, s59, 4
s_add_u32 s62, s62, s63
s_cmp_ge_u32 s59, 224
s_cselect_b32 s62, 0x7f000000, s62
buffer_load_dwordx4 v18, s[28:31], s62 offen lds
s_lshr_b32 s62, s3, 1
s_add_u32 s62, s62, s59
s_add_u32 s62, s62, 6
s_and_b32 s62, s62, 7
s_lshr_b32 s63, s62, 1
s_lshl_b32 s63, s63, 2
s_and_b32 s70, s62, 1
s_add_u32 s63, s63, s70
s_and_b32 s70, s3, 1
s_lshl_b32 s70, s70, 1
s_add_u32 s63, s63, s70
s_lshl_b32 s63, s63, 10
s_add_u32 m0, s63, 131072
s_mul_i32 s62, s62, 229376
s_lshl_b32 s63, s59, 4
s_add_u32 s62, s62, s63
s_cmp_ge_u32 s59, 224
s_cselect_b32 s62, 0x7f000000, s62
buffer_load_dwordx4 v18, s[28:31], s62 offen lds
v_lshlrev_b32 v32, 16, v48
v_and_b32 v33, 0xffff0000, v48
v_lshlrev_b32 v34, 16, v49
v_and_b32 v35, 0xffff0000, v49
v_lshlrev_b32 v36, 16, v50
v_and_b32 v37, 0xffff0000, v50
v_lshlrev_b32 v38, 16, v51
v_and_b32 v39, 0xffff0000, v51
v_lshlrev_b32 v40, 16, v52
v_and_b32 v41, 0xffff0000, v52
v_lshlrev_b32 v42, 16, v53
v_and_b32 v43, 0xffff0000, v53
v_lshlrev_b32 v44, 16, v54
v_and_b32 v45, 0xffff0000, v54
v_lshlrev_b32 v46, 16, v55
v_and_b32 v47, 0xffff0000, v55
v_pk_add_f32 v[32:33], v[32:33], v[80:81]
v_pk_add_f32 v[34:35], v[34:35], v[82:83]
v_pk_add_f32 v[36:37], v[36:37], v[84:85]
v_pk_add_f32 v[38:39], v[38:39], v[86:87]
v_pk_add_f32 v[40:41], v[40:41], v[88:89]
v_pk_add_f32 v[42:43], v[42:43], v[90:91]
v_pk_add_f32 v[44:45], v[44:45], v[92:93]
v_pk_add_f32 v[46:47], v[46:47], v[94:95]
v_cvt_pk_bf16_f32 v56, v32, v33
v_cvt_pk_bf16_f32 v57, v34, v35
v_cvt_pk_bf16_f32 v58, v36, v37
v_cvt_pk_bf16_f32 v59, v38, v39
v_cvt_pk_bf16_f32 v60, v40, v41
v_cvt_pk_bf16_f32 v61, v42, v43
v_cvt_pk_bf16_f32 v62, v44, v45
v_cvt_pk_bf16_f32 v63, v46, v47
v_mov_b32 v24, 151552
v_and_b32 v25, 31, v0
v_mul_u32_u24 v25, 272, v25
v_and_b32 v26, 0xff, v7
v_add_u32 v25, v25, v26
ds_write_b128 v25, v[56:59] offset:32768
ds_write_b128 v25, v[60:63] offset:32784
v_lshrrev_b32 v25, 4, v0
s_lshl_b32 s62, s3, 3
v_add_u32 v25, s62, v25
v_and_b32 v26, 15, v0
v_lshlrev_b32 v26, 4, v26
v_mul_u32_u24 v27, 272, v25
v_add_u32 v27, v27, v26
s_lshl_b32 s62, s65, 5
v_add_u32 v25, s62, v25
v_lshl_add_u32 v26, v25, 10, v26
v_sub_u32 v25, 2047, v25
v_subrev_u32 v28, 4, v25
s_lshl_b32 s62, s66, 8
s_add_u32 s63, s62, 4096
s_waitcnt vmcnt(0) lgkmcnt(0)

s_barrier
ds_read_b32 v24, v24
ds_read_b128 v[56:59], v27 offset:32768
ds_read_b128 v[60:63], v27 offset:33856
s_waitcnt lgkmcnt(0)
v_and_b32 v24, 0x7ff, v24
v_cmp_ne_u32 vcc, v24, v25
v_cmp_ne_u32 s[56:57], v24, v28
s_cmp_ge_u32 s59, 224
s_cbranch_scc1 L_outgo
s_barrier
s_barrier
L_outgo:

s_mov_b64 exec, vcc
buffer_store_dwordx4 v[56:59], v26, s[24:27], s62 offen sc0 sc1
s_mov_b64 exec, s[56:57]
buffer_store_dwordx4 v[60:63], v26, s[24:27], s63 offen sc0 sc1
s_mov_b64 exec, -1
s_endpgm
L_compute:
s_and_b32 s56, s3, 1
s_lshr_b32 s57, s3, 1
s_getpc_b64 s[62:63]
L_pc:
s_sub_u32 s62, s62, L_pc-L_start
s_subb_u32 s63, s63, 0
s_lshr_b32 s60, s2, 3
s_lshl_b32 s60, s60, 2
s_add_u32 s60, s60, s3
s_lshl_b32 s60, s60, 8
v_and_b32 v31, 1, v0
v_lshl_add_u32 v31, v31, 7, s60
v_min_u32 v31, L_cold-L_start, v31
global_load_dword v112, v31, s[62:63]
v_lshlrev_b32 v1, 4, v0
v_lshrrev_b32 v28, 5, v0
v_and_b32 v29, 15, v0
v_lshl_add_u32 v29, v28, 4, v29
v_lshlrev_b32 v29, 4, v29
v_add_u32 v3, 1024, v29
v_lshlrev_b32 v22, 2, v0
v_add_u32 v22, 1024, v22
s_lshl_b32 s58, s5, 1
s_add_u32 s58, s58, s57
s_lshl_b32 s58, s58, 7
s_lshl_b32 s60, s4, 1
s_add_u32 s58, s58, s60
s_add_u32 s58, s58, s56
s_mul_i32 s58, s58, 2304
s_add_u32 s58, s58, 1048576
s_lshl_b32 s59, s4, 4
s_add_u32 s59, s59, s5
s_lshl_b32 s59, s59, 2
s_add_u32 s59, s59, s3
s_mul_i32 s59, s59, 1280
s_add_u32 s59, s59, 5767168
s_add_u32 s61, s58, 147456
s_add_u32 s64, s59, 40960
s_and_b32 s66, s2, 7
s_lshr_b32 s67, s2, 3
s_mul_i32 s65, s66, 28
s_add_u32 s65, s65, s67
s_lshl_b32 s66, s66, 2
s_add_u32 s66, s66, s67
s_add_u32 s66, s66, 196
s_cmp_ge_u32 s67, 28
s_cselect_b32 s65, s66, s65
s_waitcnt lgkmcnt(0)
s_load_dword s6, s[54:55], 0
s_mov_b32 s16, s54
s_mov_b32 s17, s55
s_mov_b32 s18, 16777216
s_mov_b32 s19, 0x00020000
s_mov_b32 s24, s52
s_mov_b32 s25, s53
s_mov_b32 s26, 2097152
s_mov_b32 s27, 0x00020000
v_and_b32 v29, 31, v0
s_lshl_b32 s60, s56, 5
v_add_u32 v29, s60, v29
v_bfe_u32 v30, v29, 1, 3
v_xor_b32 v30, v30, v28
v_lshlrev_b32 v31, 7, v29
v_lshl_add_u32 v4, v30, 4, v31
s_lshl_b32 s60, s3, 5
v_xor_b32 v4, s60, v4
v_xor_b32 v5, 32, v4
v_xor_b32 v6, 64, v4
v_xor_b32 v7, 96, v4
v_bfe_u32 v29, v0, 2, 2
v_lshl_add_u32 v30, v28, 3, v29
v_lshlrev_b32 v30, 7, v30
v_lshrrev_b32 v29, 1, v29
v_xor_b32 v29, s57, v29
v_lshl_add_u32 v30, v29, 6, v30
v_and_b32 v29, 16, v0
v_lshl_add_u32 v30, v29, 1, v30
v_and_b32 v29, 3, v0
v_lshl_add_u32 v9, v29, 3, v30
s_lshl_b32 s60, s3, 11
s_add_u32 s60, s60, 65536
v_add_u32 v8, s60, v9
v_xor_b32 v9, 2048, v8
v_xor_b32 v23, 4096, v8
v_xor_b32 v2, 6144, v8
v_mov_b32 v122, 0
v_mov_b32 v123, 0
v_mov_b32 v124, 0
v_mov_b32 v125, 0
s_mov_b32 s8, 0xaaaaaaaa
s_mov_b32 s9, 0xaaaaaaaa
s_mov_b32 s10, 0xcccccccc
s_mov_b32 s11, 0xcccccccc
s_lshl_b32 s60, s3, 10
s_add_u32 s60, s60, 131072
v_add_u32 v104, s60, v1
v_xor_b32 v105, 2048, v104
v_xor_b32 v106, 1024, v104
s_lshl_b32 s70, s3, 7
s_add_u32 s70, s70, 155648
v_and_b32 v107, 31, v0
v_lshl_add_u32 v107, v107, 2, s70
v_mov_b32 v10, 0
v_mov_b32 v11, 0
v_mov_b32 v12, 0
v_mov_b32 v13, 0
s_mov_b32 s22, 1065369472
s_mov_b32 s23, 1065369472
s_lshl_b32 s60, s57, 2
s_add_u32 s60, s60, s56
s_lshl_b32 s68, s60, 11
s_add_u32 s68, s68, 131072
v_lshrrev_b32 v16, 1, v0
v_xor_b32 v16, v16, v28
v_and_b32 v16, 1, v16
v_bfe_u32 v18, v0, 2, 1
v_lshl_add_u32 v16, v16, 1, v18
v_mov_b32 v18, 0x3f003f00
v_cmp_eq_u32 vcc, 0, v16
s_nop 1
v_cndmask_b32 v28, 0, v18, vcc
v_cndmask_b32 v29, 0, v18, vcc
v_cmp_eq_u32 vcc, 1, v16
s_nop 1
v_cndmask_b32 v30, 0, v18, vcc
v_cndmask_b32 v31, 0, v18, vcc
v_and_b32 v16, 1, v0
v_mul_u32_u24 v16, 0xaaaa, v16
s_lshl_b32 s60, s5, 2
s_add_u32 s60, s60, s3
s_lshl_b32 s60, s60, 5
s_add_u32 s60, s60, s4
s_mul_i32 s60, s60, 4608
s_add_u32 s60, s60, 1030144
s_mov_b32 s100, 0xffff
s_mov_b32 s101, 0xffff
s_waitcnt lgkmcnt(0)
v_add_u32 v15, 0x4444, v16
s_mul_i32 s6, s6, 0x9E3779B1
s_add_u32 s6, s6, 0x7F4A7C15
s_lshl_b32 s62, s6, 1
s_add_u32 s63, s6, 4227988480
s_add_u32 s96, s60, 0
s_cmp_ge_u32 s4, 4
s_cselect_b32 s96, s96, 0x7f000000
s_cselect_b32 s12, s62, 0
s_add_u32 s97, s60, 4608
s_cmp_ge_u32 s4, 3
s_cselect_b32 s97, s97, 0x7f000000
s_cselect_b32 s13, s62, 0
s_add_u32 s98, s60, 9216
s_cmp_ge_u32 s4, 2
s_cselect_b32 s98, s98, 0x7f000000
s_cselect_b32 s14, s62, 0
s_add_u32 s99, s60, 13824
s_cmp_ge_u32 s4, 1
s_cselect_b32 s99, s99, 0x7f000000
s_cselect_b32 s15, s62, 0
v_mov_b32 v17, 0
v_mov_b32 v19, 0
v_mov_b32 v20, 0
v_mov_b32 v21, 0
v_mov_b32 v25, 0
v_mov_b32 v26, 0
v_mov_b32 v27, 0
s_barrier
ds_read_b128 v[128:131], v4 offset:0
ds_read_b64_tr_b16 v[32:33], v8 offset:0
ds_read_b64_tr_b16 v[34:35], v8 offset:512
ds_read_b64_tr_b16 v[36:37], v8 offset:8192
ds_read_b64_tr_b16 v[38:39], v8 offset:8704
ds_read_b128 v[132:135], v5 offset:0
ds_read_b64_tr_b16 v[40:41], v9 offset:0
ds_read_b64_tr_b16 v[42:43], v9 offset:512
ds_read_b64_tr_b16 v[44:45], v9 offset:8192
ds_read_b64_tr_b16 v[46:47], v9 offset:8704
ds_read_b128 v[136:139], v6 offset:0
ds_read_b64_tr_b16 v[48:49], v23 offset:0
ds_read_b64_tr_b16 v[50:51], v23 offset:512
ds_read_b64_tr_b16 v[52:53], v23 offset:8192
ds_read_b64_tr_b16 v[54:55], v23 offset:8704
s_waitcnt lgkmcnt(10)
v_mfma_f32_32x32x16_bf16 v[64:79], v[32:35], v[128:131], 0
ds_read_b128 v[140:143], v7 offset:0
ds_read_b64_tr_b16 v[56:57], v2 offset:0
v_mfma_f32_32x32x16_bf16 v[80:95], v[128:131], v[36:39], 0
ds_read_b64_tr_b16 v[58:59], v2 offset:512
ds_read_b64_tr_b16 v[60:61], v2 offset:8192
ds_read_b64_tr_b16 v[62:63], v2 offset:8704
v_smfmac_f32_16x16x64_bf16 v[10:13], v[28:31], v[32:39], v15
s_waitcnt lgkmcnt(10)
s_barrier
v_mfma_f32_32x32x16_bf16 v[64:79], v[40:43], v[132:135], v[64:79]
ds_read_b128 v[144:147], v4 offset:8192
ds_read_b64_tr_b16 v[32:33], v8 offset:16384
v_mfma_f32_32x32x16_bf16 v[80:95], v[132:135], v[44:47], v[80:95]
ds_read_b64_tr_b16 v[34:35], v8 offset:16896
ds_read_b64_tr_b16 v[36:37], v8 offset:24576
ds_read_b64_tr_b16 v[38:39], v8 offset:25088
v_mfma_f32_4x4x4_16b_bf16 v[114:117], v[128:129], v[128:129], 0
v_smfmac_f32_16x16x64_bf16 v[122:125], v[28:31], v[128:135], v15
v_mfma_f32_4x4x4_16b_bf16 v[118:121], v[130:131], v[130:131], 0
s_waitcnt lgkmcnt(10)
v_mfma_f32_32x32x16_bf16 v[64:79], v[48:51], v[136:139], v[64:79]
ds_read_b128 v[148:151], v5 offset:8192
ds_read_b64_tr_b16 v[40:41], v9 offset:16384
v_mfma_f32_32x32x16_bf16 v[80:95], v[136:139], v[52:55], v[80:95]
ds_read_b64_tr_b16 v[42:43], v9 offset:16896
ds_read_b64_tr_b16 v[44:45], v9 offset:24576
ds_read_b64_tr_b16 v[46:47], v9 offset:25088
v_smfmac_f32_16x16x64_bf16 v[10:13], v[28:31], v[48:55], v15
s_waitcnt lgkmcnt(10)
v_mfma_f32_32x32x16_bf16 v[64:79], v[56:59], v[140:143], v[64:79]
ds_read_b128 v[152:155], v6 offset:8192
ds_read_b64_tr_b16 v[48:49], v23 offset:16384
v_mfma_f32_32x32x16_bf16 v[80:95], v[140:143], v[60:63], v[80:95]
ds_read_b64_tr_b16 v[50:51], v23 offset:16896
ds_read_b64_tr_b16 v[52:53], v23 offset:24576
ds_read_b64_tr_b16 v[54:55], v23 offset:25088
v_mfma_f32_4x4x4_16b_bf16 v[114:117], v[132:133], v[132:133], v[114:117]
v_mfma_f32_4x4x4_16b_bf16 v[118:121], v[134:135], v[134:135], v[118:121]
s_waitcnt lgkmcnt(10)
v_mfma_f32_32x32x16_bf16 v[64:79], v[32:35], v[144:147], v[64:79]
ds_read_b128 v[156:159], v7 offset:8192
ds_read_b64_tr_b16 v[56:57], v2 offset:16384
v_mfma_f32_32x32x16_bf16 v[80:95], v[144:147], v[36:39], v[80:95]
ds_read_b64_tr_b16 v[58:59], v2 offset:16896
ds_read_b64_tr_b16 v[60:61], v2 offset:24576
ds_read_b64_tr_b16 v[62:63], v2 offset:25088
v_smfmac_f32_16x16x64_bf16 v[10:13], v[28:31], v[32:39], v15
s_waitcnt lgkmcnt(10)
s_barrier
v_mfma_f32_32x32x16_bf16 v[64:79], v[40:43], v[148:151], v[64:79]
ds_read_b128 v[160:163], v4 offset:16384
ds_read_b64_tr_b16 v[32:33], v8 offset:32768
v_mfma_f32_32x32x16_bf16 v[80:95], v[148:151], v[44:47], v[80:95]
ds_read_b64_tr_b16 v[34:35], v8 offset:33280
ds_read_b64_tr_b16 v[36:37], v8 offset:40960
ds_read_b64_tr_b16 v[38:39], v8 offset:41472
v_mfma_f32_4x4x4_16b_bf16 v[114:117], v[144:145], v[144:145], v[114:117]
v_smfmac_f32_16x16x64_bf16 v[122:125], v[28:31], v[144:151], v15
v_mfma_f32_4x4x4_16b_bf16 v[118:121], v[146:147], v[146:147], v[118:121]
s_waitcnt lgkmcnt(10)
v_mfma_f32_32x32x16_bf16 v[64:79], v[48:51], v[152:155], v[64:79]
ds_read_b128 v[164:167], v5 offset:16384
ds_read_b64_tr_b16 v[40:41], v9 offset:32768
v_mfma_f32_32x32x16_bf16 v[80:95], v[152:155], v[52:55], v[80:95]
ds_read_b64_tr_b16 v[42:43], v9 offset:33280
ds_read_b64_tr_b16 v[44:45], v9 offset:40960
ds_read_b64_tr_b16 v[46:47], v9 offset:41472
v_smfmac_f32_16x16x64_bf16 v[10:13], v[28:31], v[48:55], v15
s_waitcnt lgkmcnt(10)
v_mfma_f32_32x32x16_bf16 v[64:79], v[56:59], v[156:159], v[64:79]
ds_read_b128 v[168:171], v6 offset:16384
ds_read_b64_tr_b16 v[48:49], v23 offset:32768
v_mfma_f32_32x32x16_bf16 v[80:95], v[156:159], v[60:63], v[80:95]
ds_read_b64_tr_b16 v[50:51], v23 offset:33280
ds_read_b64_tr_b16 v[52:53], v23 offset:40960
ds_read_b64_tr_b16 v[54:55], v23 offset:41472
v_mfma_f32_4x4x4_16b_bf16 v[114:117], v[148:149], v[148:149], v[114:117]
v_mfma_f32_4x4x4_16b_bf16 v[118:121], v[150:151], v[150:151], v[118:121]
s_waitcnt lgkmcnt(10)
v_mfma_f32_32x32x16_bf16 v[64:79], v[32:35], v[160:163], v[64:79]
ds_read_b128 v[172:175], v7 offset:16384
ds_read_b64_tr_b16 v[56:57], v2 offset:32768
v_mfma_f32_32x32x16_bf16 v[80:95], v[160:163], v[36:39], v[80:95]
ds_read_b64_tr_b16 v[58:59], v2 offset:33280
ds_read_b64_tr_b16 v[60:61], v2 offset:40960
ds_read_b64_tr_b16 v[62:63], v2 offset:41472
v_smfmac_f32_16x16x64_bf16 v[10:13], v[28:31], v[32:39], v15
s_waitcnt lgkmcnt(10)
s_barrier
v_mfma_f32_32x32x16_bf16 v[64:79], v[40:43], v[164:167], v[64:79]
ds_read_b128 v[176:179], v4 offset:24576
ds_read_b64_tr_b16 v[32:33], v8 offset:49152
v_mfma_f32_32x32x16_bf16 v[80:95], v[164:167], v[44:47], v[80:95]
ds_read_b64_tr_b16 v[34:35], v8 offset:49664
ds_read_b64_tr_b16 v[36:37], v8 offset:57344
ds_read_b64_tr_b16 v[38:39], v8 offset:57856
v_mfma_f32_4x4x4_16b_bf16 v[114:117], v[160:161], v[160:161], v[114:117]
v_smfmac_f32_16x16x64_bf16 v[122:125], v[28:31], v[160:167], v15
v_mfma_f32_4x4x4_16b_bf16 v[118:121], v[162:163], v[162:163], v[118:121]
s_waitcnt lgkmcnt(10)
v_mfma_f32_32x32x16_bf16 v[64:79], v[48:51], v[168:171], v[64:79]
ds_read_b128 v[180:183], v5 offset:24576
ds_read_b64_tr_b16 v[40:41], v9 offset:49152
v_mfma_f32_32x32x16_bf16 v[80:95], v[168:171], v[52:55], v[80:95]
ds_read_b64_tr_b16 v[42:43], v9 offset:49664
ds_read_b64_tr_b16 v[44:45], v9 offset:57344
ds_read_b64_tr_b16 v[46:47], v9 offset:57856
v_smfmac_f32_16x16x64_bf16 v[10:13], v[28:31], v[48:55], v15
s_waitcnt lgkmcnt(10)
v_mfma_f32_32x32x16_bf16 v[64:79], v[56:59], v[172:175], v[64:79]
ds_read_b128 v[184:187], v6 offset:24576
ds_read_b64_tr_b16 v[48:49], v23 offset:49152
v_mfma_f32_32x32x16_bf16 v[80:95], v[172:175], v[60:63], v[80:95]
ds_read_b64_tr_b16 v[50:51], v23 offset:49664
ds_read_b64_tr_b16 v[52:53], v23 offset:57344
ds_read_b64_tr_b16 v[54:55], v23 offset:57856
v_mfma_f32_4x4x4_16b_bf16 v[114:117], v[164:165], v[164:165], v[114:117]
v_mfma_f32_4x4x4_16b_bf16 v[118:121], v[166:167], v[166:167], v[118:121]
s_waitcnt lgkmcnt(10)
v_mfma_f32_32x32x16_bf16 v[64:79], v[32:35], v[176:179], v[64:79]
ds_read_b128 v[188:191], v7 offset:24576
ds_read_b64_tr_b16 v[56:57], v2 offset:49152
v_mfma_f32_32x32x16_bf16 v[80:95], v[176:179], v[36:39], v[80:95]
ds_read_b64_tr_b16 v[58:59], v2 offset:49664
ds_read_b64_tr_b16 v[60:61], v2 offset:57344
ds_read_b64_tr_b16 v[62:63], v2 offset:57856
v_smfmac_f32_16x16x64_bf16 v[10:13], v[28:31], v[32:39], v15
s_waitcnt lgkmcnt(10)
s_barrier
v_mfma_f32_32x32x16_bf16 v[64:79], v[40:43], v[180:183], v[64:79]
ds_read_b128 v[192:195], v4 offset:32768
v_add_u32 v8, 65536, v8
ds_read_b64_tr_b16 v[32:33], v8 offset:0
v_mfma_f32_32x32x16_bf16 v[80:95], v[180:183], v[44:47], v[80:95]
ds_read_b64_tr_b16 v[34:35], v8 offset:512
ds_read_b64_tr_b16 v[36:37], v8 offset:8192
ds_read_b64_tr_b16 v[38:39], v8 offset:8704
v_mfma_f32_4x4x4_16b_bf16 v[114:117], v[176:177], v[176:177], v[114:117]
v_smfmac_f32_16x16x64_bf16 v[122:125], v[28:31], v[176:183], v15
v_mfma_f32_4x4x4_16b_bf16 v[118:121], v[178:179], v[178:179], v[118:121]
s_waitcnt lgkmcnt(10)
v_mfma_f32_32x32x16_bf16 v[64:79], v[48:51], v[184:187], v[64:79]
ds_read_b128 v[196:199], v5 offset:32768
v_add_u32 v9, 65536, v9
ds_read_b64_tr_b16 v[40:41], v9 offset:0
v_mfma_f32_32x32x16_bf16 v[80:95], v[184:187], v[52:55], v[80:95]
ds_read_b64_tr_b16 v[42:43], v9 offset:512
ds_read_b64_tr_b16 v[44:45], v9 offset:8192
ds_read_b64_tr_b16 v[46:47], v9 offset:8704
v_smfmac_f32_16x16x64_bf16 v[10:13], v[28:31], v[48:55], v15
s_waitcnt lgkmcnt(10)
v_mfma_f32_32x32x16_bf16 v[64:79], v[56:59], v[188:191], v[64:79]
ds_read_b128 v[200:203], v6 offset:32768
v_add_u32 v23, 65536, v23
ds_read_b64_tr_b16 v[48:49], v23 offset:0
v_mfma_f32_32x32x16_bf16 v[80:95], v[188:191], v[60:63], v[80:95]
ds_read_b64_tr_b16 v[50:51], v23 offset:512
ds_read_b64_tr_b16 v[52:53], v23 offset:8192
ds_read_b64_tr_b16 v[54:55], v23 offset:8704
v_mfma_f32_4x4x4_16b_bf16 v[114:117], v[180:181], v[180:181], v[114:117]
v_mfma_f32_4x4x4_16b_bf16 v[118:121], v[182:183], v[182:183], v[118:121]
s_waitcnt lgkmcnt(10)
v_mfma_f32_32x32x16_bf16 v[64:79], v[32:35], v[192:195], v[64:79]
ds_read_b128 v[204:207], v7 offset:32768
v_add_u32 v2, 65536, v2
ds_read_b64_tr_b16 v[56:57], v2 offset:0
v_mfma_f32_32x32x16_bf16 v[80:95], v[192:195], v[36:39], v[80:95]
ds_read_b64_tr_b16 v[58:59], v2 offset:512
ds_read_b64_tr_b16 v[60:61], v2 offset:8192
ds_read_b64_tr_b16 v[62:63], v2 offset:8704
v_smfmac_f32_16x16x64_bf16 v[10:13], v[28:31], v[32:39], v15
s_waitcnt lgkmcnt(10)
s_barrier
v_mfma_f32_32x32x16_bf16 v[64:79], v[40:43], v[196:199], v[64:79]
ds_read_b128 v[208:211], v4 offset:40960
ds_read_b64_tr_b16 v[32:33], v8 offset:16384
ds_read_b64_tr_b16 v[34:35], v8 offset:16896
v_mfma_f32_32x32x16_bf16 v[80:95], v[196:199], v[44:47], v[80:95]
ds_read_b64_tr_b16 v[36:37], v8 offset:24576
ds_read_b64_tr_b16 v[38:39], v8 offset:25088
ds_read_b128 v[224:227], v4 offset:49152
ds_read_b128 v[228:231], v5 offset:49152
v_mfma_f32_4x4x4_16b_bf16 v[114:117], v[192:193], v[192:193], v[114:117]
v_smfmac_f32_16x16x64_bf16 v[122:125], v[28:31], v[192:199], v15
v_mfma_f32_4x4x4_16b_bf16 v[118:121], v[194:195], v[194:195], v[118:121]
s_waitcnt lgkmcnt(12)
v_mfma_f32_32x32x16_bf16 v[64:79], v[48:51], v[200:203], v[64:79]
ds_read_b128 v[212:215], v5 offset:40960
ds_read_b64_tr_b16 v[40:41], v9 offset:16384
ds_read_b64_tr_b16 v[42:43], v9 offset:16896
v_mfma_f32_32x32x16_bf16 v[80:95], v[200:203], v[52:55], v[80:95]
ds_read_b64_tr_b16 v[44:45], v9 offset:24576
ds_read_b64_tr_b16 v[46:47], v9 offset:25088
ds_read_b128 v[240:243], v4 offset:57344
ds_read_b128 v[244:247], v5 offset:57344
v_smfmac_f32_16x16x64_bf16 v[10:13], v[28:31], v[48:55], v15
s_waitcnt lgkmcnt(14)
v_mfma_f32_32x32x16_bf16 v[64:79], v[56:59], v[204:207], v[64:79]
ds_read_b128 v[216:219], v6 offset:40960
ds_read_b64_tr_b16 v[48:49], v23 offset:16384
ds_read_b64_tr_b16 v[50:51], v23 offset:16896
v_mfma_f32_32x32x16_bf16 v[80:95], v[204:207], v[60:63], v[80:95]
ds_read_b64_tr_b16 v[52:53], v23 offset:24576
ds_read_b64_tr_b16 v[54:55], v23 offset:25088
ds_read_b128 v[232:235], v6 offset:49152
ds_read_b128 v[236:239], v7 offset:49152
v_mfma_f32_4x4x4_16b_bf16 v[114:117], v[196:197], v[196:197], v[114:117]
v_mfma_f32_4x4x4_16b_bf16 v[118:121], v[198:199], v[198:199], v[118:121]
s_waitcnt lgkmcnt(15)
v_mfma_f32_32x32x16_bf16 v[64:79], v[32:35], v[208:211], v[64:79]
ds_read_b128 v[220:223], v7 offset:40960
ds_read_b64_tr_b16 v[56:57], v2 offset:16384
ds_read_b64_tr_b16 v[58:59], v2 offset:16896
v_mfma_f32_32x32x16_bf16 v[80:95], v[208:211], v[36:39], v[80:95]
ds_read_b64_tr_b16 v[60:61], v2 offset:24576
ds_read_b64_tr_b16 v[62:63], v2 offset:25088
ds_read_b128 v[248:251], v6 offset:57344
ds_read_b128 v[252:255], v7 offset:57344
v_smfmac_f32_16x16x64_bf16 v[10:13], v[28:31], v[32:39], v15
s_waitcnt lgkmcnt(15)
v_mfma_f32_4x4x4_16b_bf16 v[114:117], v[224:225], v[224:225], v[114:117]
v_smfmac_f32_16x16x64_bf16 v[122:125], v[28:31], v[224:231], v15
v_mfma_f32_4x4x4_16b_bf16 v[118:121], v[226:227], v[226:227], v[118:121]
s_waitcnt lgkmcnt(15)
s_barrier
v_mfma_f32_32x32x16_bf16 v[64:79], v[40:43], v[212:215], v[64:79]
v_add_u32 v8, -65536, v8
ds_read_b64_tr_b16 v[32:33], v8 offset:0
ds_read_b64_tr_b16 v[34:35], v8 offset:512
v_mfma_f32_32x32x16_bf16 v[80:95], v[212:215], v[44:47], v[80:95]
ds_read_b64_tr_b16 v[36:37], v8 offset:8192
ds_read_b64_tr_b16 v[38:39], v8 offset:8704
v_mfma_f32_4x4x4_16b_bf16 v[114:117], v[208:209], v[208:209], v[114:117]
v_smfmac_f32_16x16x64_bf16 v[122:125], v[28:31], v[208:215], v15
v_mfma_f32_4x4x4_16b_bf16 v[118:121], v[210:211], v[210:211], v[118:121]
s_waitcnt lgkmcnt(13)
v_mfma_f32_32x32x16_bf16 v[64:79], v[48:51], v[216:219], v[64:79]
v_add_u32 v9, -65536, v9
ds_read_b64_tr_b16 v[40:41], v9 offset:0
ds_read_b64_tr_b16 v[42:43], v9 offset:512
v_mfma_f32_32x32x16_bf16 v[80:95], v[216:219], v[52:55], v[80:95]
ds_read_b64_tr_b16 v[44:45], v9 offset:8192
ds_read_b64_tr_b16 v[46:47], v9 offset:8704
v_smfmac_f32_16x16x64_bf16 v[10:13], v[28:31], v[48:55], v15
v_mfma_f32_4x4x4_16b_bf16 v[114:117], v[228:229], v[228:229], v[114:117]
v_mfma_f32_4x4x4_16b_bf16 v[118:121], v[230:231], v[230:231], v[118:121]
s_waitcnt lgkmcnt(15)
v_mfma_f32_4x4x4_16b_bf16 v[114:117], v[240:241], v[240:241], v[114:117]
v_smfmac_f32_16x16x64_bf16 v[122:125], v[28:31], v[240:247], v15
v_mfma_f32_4x4x4_16b_bf16 v[118:121], v[242:243], v[242:243], v[118:121]
s_waitcnt lgkmcnt(10)
v_mfma_f32_32x32x16_bf16 v[64:79], v[56:59], v[220:223], v[64:79]
v_add_u32 v23, -65536, v23
ds_read_b64_tr_b16 v[48:49], v23 offset:0
ds_read_b64_tr_b16 v[50:51], v23 offset:512
v_add_f32 v98, v10, v11
v_add_f32 v99, v12, v13
v_mfma_f32_32x32x16_bf16 v[80:95], v[220:223], v[60:63], v[80:95]
ds_read_b64_tr_b16 v[52:53], v23 offset:8192
ds_read_b64_tr_b16 v[54:55], v23 offset:8704
v_mfma_f32_4x4x4_16b_bf16 v[114:117], v[212:213], v[212:213], v[114:117]
v_mfma_f32_4x4x4_16b_bf16 v[118:121], v[214:215], v[214:215], v[118:121]
s_nop 0
v_mfma_f32_4x4x4_16b_bf16 v[114:117], v[244:245], v[244:245], v[114:117]
v_mfma_f32_4x4x4_16b_bf16 v[118:121], v[246:247], v[246:247], v[118:121]
s_waitcnt lgkmcnt(8)
v_mfma_f32_32x32x16_bf16 v[64:79], v[32:35], v[224:227], v[64:79]
v_add_u32 v2, -65536, v2
ds_read_b64_tr_b16 v[56:57], v2 offset:0
ds_read_b64_tr_b16 v[58:59], v2 offset:512
v_add_f32 v122, v122, v123
v_add_f32 v124, v124, v125
v_cndmask_b32_e64 v114, v114, v115, s[8:9]
v_cndmask_b32_e64 v116, v116, v117, s[8:9]
v_mfma_f32_32x32x16_bf16 v[80:95], v[224:227], v[36:39], v[80:95]
ds_read_b64_tr_b16 v[60:61], v2 offset:8192
ds_read_b64_tr_b16 v[62:63], v2 offset:8704
v_cndmask_b32_e64 v118, v118, v119, s[8:9]
v_cndmask_b32_e64 v120, v120, v121, s[8:9]
v_add_f32 v114, v114, v118
v_add_f32 v116, v116, v120
v_smfmac_f32_16x16x64_bf16 v[10:13], v[28:31], v[32:39], v15
s_waitcnt vmcnt(0)
s_waitcnt lgkmcnt(8)
v_mfma_f32_32x32x16_bf16 v[64:79], v[40:43], v[228:231], v[64:79]
v_add_f32 v96, v122, v124
v_cndmask_b32_e64 v97, v114, v116, s[10:11]
v_cndmask_b32_e64 v115, v114, v116, s[10:11]
v_lshrrev_b32 v5, 5, v0
v_mfma_f32_32x32x16_bf16 v[80:95], v[228:231], v[44:47], v[80:95]
v_lshl_add_u32 v5, v5, 4, s70
v_permlane32_swap_b32 v97, v115
v_bfe_u32 v6, v0, 4, 1
v_add_f32 v97, v97, v115
v_smfmac_f32_16x16x64_bf16 v[10:13], v[28:31], v[40:47], v15
s_waitcnt lgkmcnt(4)
v_mfma_f32_32x32x16_bf16 v[64:79], v[48:51], v[232:235], v[64:79]
ds_write_b128 v104, v[96:99]
v_lshl_add_u32 v4, v6, 12, v3
v_add_u32 v4, s68, v4
v_mul_u32_u24 v6, 147456, v6
v_mfma_f32_32x32x16_bf16 v[80:95], v[232:235], v[52:55], v[80:95]
v_add_u32 v6, v6, v3
v_add_u32 v7, s68, v1
v_smfmac_f32_16x16x64_bf16 v[10:13], v[28:31], v[48:55], v15
s_waitcnt lgkmcnt(1)
s_waitcnt lgkmcnt(0)
s_barrier
s_setprio 2
ds_read_b64_tr_b16 v[32:33], v8 offset:16384
ds_read_b64_tr_b16 v[34:35], v8 offset:16896
ds_read_b64_tr_b16 v[36:37], v8 offset:24576
ds_read_b64_tr_b16 v[38:39], v8 offset:25088
ds_read_b64 v[100:101], v105
ds_read_b64 v[102:103], v106 offset:8
v_mfma_f32_32x32x16_bf16 v[64:79], v[56:59], v[236:239], v[64:79]
ds_read_b64_tr_b16 v[40:41], v9 offset:16384
ds_read_b64_tr_b16 v[42:43], v9 offset:16896
ds_read_b64_tr_b16 v[44:45], v9 offset:24576
v_mfma_f32_32x32x16_bf16 v[80:95], v[236:239], v[60:63], v[80:95]
ds_read_b64_tr_b16 v[46:47], v9 offset:25088
ds_read_b64_tr_b16 v[48:49], v23 offset:16384
ds_read_b64_tr_b16 v[50:51], v23 offset:16896
ds_read_b64_tr_b16 v[52:53], v23 offset:24576
v_smfmac_f32_16x16x64_bf16 v[10:13], v[28:31], v[56:63], v15
s_waitcnt lgkmcnt(9)
v_mfma_f32_32x32x16_bf16 v[64:79], v[32:35], v[240:243], v[64:79]
ds_read_b64_tr_b16 v[54:55], v23 offset:25088
ds_read_b64_tr_b16 v[56:57], v2 offset:16384
s_waitcnt lgkmcnt(9)
v_add_f32 v96, v96, v100
v_add_f32 v97, v97, v101
v_mul_f32 v108, 0x3b800000, v96
v_mul_f32 v97, 0x3b000000, v97
v_mfma_f32_32x32x16_bf16 v[80:95], v[240:243], v[36:39], v[80:95]
ds_read_b64_tr_b16 v[58:59], v2 offset:16896
ds_read_b64_tr_b16 v[60:61], v2 offset:24576
ds_read_b64_tr_b16 v[62:63], v2 offset:25088
v_fma_f32 v97, -v108, v108, v97
v_max_f32 v97, 0, v97
v_cvt_pk_bf16_f32 v109, v108, v97
v_and_b32 v97, 0xffff0000, v109
v_smfmac_f32_16x16x64_bf16 v[10:13], v[28:31], v[32:39], v15
s_waitcnt lgkmcnt(8)
v_mfma_f32_32x32x16_bf16 v[64:79], v[40:43], v[244:247], v[64:79]
v_add_f32 v97, 0x3727c5ac, v97
v_lshlrev_b32 v108, 16, v109
v_cvt_pk_bf16_f32 v97, v97, v97
v_and_b32 v97, 0xffff0000, v97
v_mfma_f32_32x32x16_bf16 v[80:95], v[244:247], v[44:47], v[80:95]
v_sqrt_f32 v97, v97
s_nop 0
v_cvt_pk_bf16_f32 v97, v97, v97
v_and_b32 v97, 0xffff0000, v97
v_rcp_f32 v14, v97
v_smfmac_f32_16x16x64_bf16 v[10:13], v[28:31], v[40:47], v15
s_waitcnt lgkmcnt(0)
v_smfmac_f32_16x16x64_bf16 v[10:13], v[28:31], v[48:55], v15
v_cvt_pk_bf16_f32 v24, -v108, -v108
ds_write_b32 v107, v14
v_smfmac_f32_16x16x64_bf16 v[10:13], v[28:31], v[56:63], v15
ds_write_b32 v107, v24 offset:512
v_mov_b32 v126, v102
v_mfma_f32_32x32x16_bf16 v[64:79], v[48:51], v[248:251], v[64:79]
v_mov_b32 v127, v103
ds_read_b128 v[96:99], v5 offset:0
ds_read_b128 v[100:103], v5 offset:32
ds_read_b128 v[104:107], v5 offset:64
ds_read_b128 v[108:111], v5 offset:96
v_mfma_f32_32x32x16_bf16 v[80:95], v[248:251], v[52:55], v[80:95]
v_add_f32 v10, v10, v11
v_add_f32 v12, v12, v13
v_add_f32 v10, v10, v126
v_add_f32 v12, v12, v127
v_mfma_f32_32x32x16_bf16 v[64:79], v[56:59], v[252:255], v[64:79]
v_and_b32 v11, 0xffff0000, v10
v_and_b32 v13, 0xffff0000, v12
v_sub_f32 v10, v10, v11
v_sub_f32 v12, v12, v13
v_cvt_pk_bf16_f32 v16, v11, v10
v_cvt_pk_bf16_f32 v18, v13, v12
s_nop 1
v_mfma_f32_32x32x16_bf16 v[64:79], v[16:19], v[24:27], v[64:79]
v_mfma_f32_32x32x16_bf16 v[80:95], v[252:255], v[60:63], v[80:95]
v_mfma_f32_32x32x16_bf16 v[80:95], v[24:27], v[18:21], v[80:95]
s_barrier
s_nop 8
v_mul_f32 v64, v64, v14
v_mul_f32 v65, v65, v14
v_mul_f32 v66, v66, v14
v_mul_f32 v67, v67, v14
v_mul_f32 v68, v68, v14
v_mul_f32 v69, v69, v14
v_mul_f32 v70, v70, v14
v_mul_f32 v71, v71, v14
v_mul_f32 v72, v72, v14
v_mul_f32 v73, v73, v14
v_mul_f32 v74, v74, v14
v_mul_f32 v75, v75, v14
v_mul_f32 v76, v76, v14
v_mul_f32 v77, v77, v14
v_mul_f32 v78, v78, v14
v_mul_f32 v79, v79, v14
v_cvt_pk_bf16_f32 v112, v64, v65
v_cvt_pk_bf16_f32 v113, v66, v67
v_cvt_pk_bf16_f32 v114, v68, v69
v_cvt_pk_bf16_f32 v115, v70, v71
buffer_store_dwordx4 v[112:115], v1, s[16:19], s58 offen sc1
v_cvt_pk_bf16_f32 v116, v72, v73
v_cvt_pk_bf16_f32 v117, v74, v75
v_cvt_pk_bf16_f32 v118, v76, v77
v_cvt_pk_bf16_f32 v119, v78, v79
buffer_store_dwordx4 v[116:119], v1, s[16:19], s61 offen sc1
v_mov_b32 v65, s63
s_waitcnt lgkmcnt(0)
v_mul_f32 v80, v80, v96
v_mul_f32 v81, v81, v97
v_mul_f32 v82, v82, v98
v_mul_f32 v83, v83, v99
v_mul_f32 v84, v84, v100
v_mul_f32 v85, v85, v101
v_mul_f32 v86, v86, v102
v_mul_f32 v87, v87, v103
v_cvt_pk_bf16_f32 v120, v80, v81
v_cvt_pk_bf16_f32 v121, v82, v83
v_cvt_pk_bf16_f32 v122, v84, v85
v_cvt_pk_bf16_f32 v123, v86, v87
buffer_store_dwordx4 v[120:123], v6, s[16:19], s58 offen offset:0 sc1
v_mul_f32 v88, v88, v104
v_mul_f32 v89, v89, v105
v_mul_f32 v90, v90, v106
v_mul_f32 v91, v91, v107
v_mul_f32 v92, v92, v108
v_mul_f32 v93, v93, v109
v_mul_f32 v94, v94, v110
v_mul_f32 v95, v95, v111
v_cvt_pk_bf16_f32 v124, v88, v89
v_cvt_pk_bf16_f32 v125, v90, v91
v_cvt_pk_bf16_f32 v126, v92, v93
v_cvt_pk_bf16_f32 v127, v94, v95
buffer_store_dwordx4 v[124:127], v6, s[16:19], s58 offen offset:512 sc1
v_add3_u32 v64, s6, v120, v121
v_add3_u32 v64, v64, v122, v123
v_add3_u32 v64, v64, v124, v125
v_add3_u32 v64, v64, v126, v127
s_nop 1
v_permlane16_swap_b32 v64, v65
v_add3_u32 v64, v64, v112, v113
v_add3_u32 v65, v65, v116, v117
v_add3_u32 v64, v64, v114, v115
v_add3_u32 v65, v65, v118, v119
buffer_store_dword v64, v22, s[16:19], s58 offen offset:1024 sc1
buffer_store_dword v65, v22, s[16:19], s61 offen offset:1024 sc1
s_setprio 0
ds_write_b128 v7, v[112:115]
ds_write_b128 v7, v[116:119] offset:4096
ds_write_b128 v4, v[120:123]
ds_write_b128 v4, v[124:127] offset:512
s_lshl_b32 s60, s3, 12
s_add_u32 s60, s60, 131072
v_add_u32 v10, s60, v1
v_add_u32 v11, s60, v3
s_lshl_b32 s60, s3, 11
s_add_u32 s60, s60, 147456
v_add_u32 v12, s60, v1
v_and_b32 v6, 31, v0
v_lshrrev_b32 v5, 5, v0
v_lshlrev_b32 v5, 2, v5
v_sub_u32 v6, v6, v5
v_mov_b32 v5, 0xf149f2ca
s_waitcnt lgkmcnt(0)
s_barrier
v_mov_b64 v[112:113], s[22:23]
v_mov_b64 v[114:115], s[22:23]
v_mov_b64 v[116:117], s[22:23]
v_mov_b64 v[118:119], s[22:23]
v_mov_b64 v[120:121], s[22:23]
v_mov_b64 v[122:123], s[22:23]
v_mov_b64 v[124:125], s[22:23]
v_mov_b64 v[126:127], s[22:23]
ds_read_b128 v[96:99], v10
ds_read_b128 v[100:103], v10 offset:2048
s_mov_b64 exec, s[100:101]
ds_read_b128 v[112:115], v11
ds_read_b128 v[116:119], v11 offset:512
ds_read_b128 v[120:123], v11 offset:2048
ds_read_b128 v[124:127], v11 offset:2560
s_mov_b64 exec, -1
s_cmp_ge_u32 s4, 1
s_cselect_b64 s[20:21], s[22:23], 0
v_mov_b64 v[136:137], s[20:21]
v_mov_b64 v[138:139], s[20:21]
v_mov_b64 v[140:141], s[20:21]
v_mov_b64 v[142:143], s[20:21]
v_mov_b64 v[144:145], s[20:21]
v_mov_b64 v[146:147], s[20:21]
v_mov_b64 v[148:149], s[20:21]
v_mov_b64 v[150:151], s[20:21]
s_cmp_ge_u32 s4, 2
s_cselect_b64 s[20:21], s[22:23], 0
v_mov_b64 v[160:161], s[20:21]
v_mov_b64 v[162:163], s[20:21]
v_mov_b64 v[164:165], s[20:21]
v_mov_b64 v[166:167], s[20:21]
v_mov_b64 v[168:169], s[20:21]
v_mov_b64 v[170:171], s[20:21]
v_mov_b64 v[172:173], s[20:21]
v_mov_b64 v[174:175], s[20:21]
s_cmp_ge_u32 s4, 3
s_cselect_b64 s[20:21], s[22:23], 0
v_mov_b64 v[184:185], s[20:21]
v_mov_b64 v[186:187], s[20:21]
v_mov_b64 v[188:189], s[20:21]
v_mov_b64 v[190:191], s[20:21]
v_mov_b64 v[192:193], s[20:21]
v_mov_b64 v[194:195], s[20:21]
v_mov_b64 v[196:197], s[20:21]
v_mov_b64 v[198:199], s[20:21]
s_cmp_ge_u32 s4, 4
s_cselect_b64 s[20:21], s[22:23], 0
v_mov_b64 v[208:209], s[20:21]
v_mov_b64 v[210:211], s[20:21]
v_mov_b64 v[212:213], s[20:21]
v_mov_b64 v[214:215], s[20:21]
v_mov_b64 v[216:217], s[20:21]
v_mov_b64 v[218:219], s[20:21]
v_mov_b64 v[220:221], s[20:21]
v_mov_b64 v[222:223], s[20:21]
v_cmp_le_i32 vcc, 0, v6
v_cmp_le_i32 s[8:9], 1, v6
s_nop 0
v_cndmask_b32_e64 v64, v5, 0, vcc
v_cndmask_b32 v80, 0, v5, vcc
v_cndmask_b32_e64 v65, v5, 0, s[8:9]
v_cndmask_b32_e64 v81, 0, v5, s[8:9]
v_cmp_le_i32 vcc, 2, v6
v_cmp_le_i32 s[8:9], 3, v6
s_nop 0
v_cndmask_b32_e64 v66, v5, 0, vcc
v_cndmask_b32 v82, 0, v5, vcc
v_cndmask_b32_e64 v67, v5, 0, s[8:9]
v_cndmask_b32_e64 v83, 0, v5, s[8:9]
v_cmp_le_i32 vcc, 8, v6
v_cmp_le_i32 s[8:9], 9, v6
s_nop 0
v_cndmask_b32_e64 v68, v5, 0, vcc
v_cndmask_b32 v84, 0, v5, vcc
v_cndmask_b32_e64 v69, v5, 0, s[8:9]
v_cndmask_b32_e64 v85, 0, v5, s[8:9]
v_cmp_le_i32 vcc, 10, v6
v_cmp_le_i32 s[8:9], 11, v6
s_nop 0
v_cndmask_b32_e64 v70, v5, 0, vcc
v_cndmask_b32 v86, 0, v5, vcc
v_cndmask_b32_e64 v71, v5, 0, s[8:9]
v_cndmask_b32_e64 v87, 0, v5, s[8:9]
v_cmp_le_i32 vcc, 16, v6
v_cmp_le_i32 s[8:9], 17, v6
s_nop 0
v_cndmask_b32_e64 v72, v5, 0, vcc
v_cndmask_b32 v88, 0, v5, vcc
v_cndmask_b32_e64 v73, v5, 0, s[8:9]
v_cndmask_b32_e64 v89, 0, v5, s[8:9]
v_cmp_le_i32 vcc, 18, v6
v_cmp_le_i32 s[8:9], 19, v6
s_nop 0
v_cndmask_b32_e64 v74, v5, 0, vcc
v_cndmask_b32 v90, 0, v5, vcc
v_cndmask_b32_e64 v75, v5, 0, s[8:9]
v_cndmask_b32_e64 v91, 0, v5, s[8:9]
v_cmp_le_i32 vcc, 24, v6
v_cmp_le_i32 s[8:9], 25, v6
s_nop 0
v_cndmask_b32_e64 v76, v5, 0, vcc
v_cndmask_b32 v92, 0, v5, vcc
v_cndmask_b32_e64 v77, v5, 0, s[8:9]
v_cndmask_b32_e64 v93, 0, v5, s[8:9]
v_cmp_le_i32 vcc, 26, v6
v_cmp_le_i32 s[8:9], 27, v6
s_nop 0
v_cndmask_b32_e64 v78, v5, 0, vcc
v_cndmask_b32 v94, 0, v5, vcc
v_cndmask_b32_e64 v79, v5, 0, s[8:9]
v_cndmask_b32_e64 v95, 0, v5, s[8:9]
s_barrier
buffer_load_dwordx4 v[128:131], v1, s[16:19], s99 offen offset:0 sc1
buffer_load_dwordx4 v[132:135], v1, s[16:19], s99 offen offset:2304 sc1
s_mov_b64 exec, s[100:101]
buffer_load_dwordx4 v[136:139], v3, s[16:19], s99 offen offset:0 sc1
buffer_load_dwordx4 v[140:143], v3, s[16:19], s99 offen offset:512 sc1
buffer_load_dwordx4 v[144:147], v3, s[16:19], s99 offen offset:2304 sc1
buffer_load_dwordx4 v[148:151], v3, s[16:19], s99 offen offset:2816 sc1
s_mov_b64 exec, -1
buffer_load_dword v4, v22, s[16:19], s99 offen offset:1024 sc1
buffer_load_dword v5, v22, s[16:19], s99 offen offset:3328 sc1
buffer_load_dwordx4 v[152:155], v1, s[16:19], s98 offen offset:0 sc1
buffer_load_dwordx4 v[156:159], v1, s[16:19], s98 offen offset:2304 sc1
s_mov_b64 exec, s[100:101]
buffer_load_dwordx4 v[160:163], v3, s[16:19], s98 offen offset:0 sc1
buffer_load_dwordx4 v[164:167], v3, s[16:19], s98 offen offset:512 sc1
buffer_load_dwordx4 v[168:171], v3, s[16:19], s98 offen offset:2304 sc1
buffer_load_dwordx4 v[172:175], v3, s[16:19], s98 offen offset:2816 sc1
s_mov_b64 exec, -1
buffer_load_dword v20, v22, s[16:19], s98 offen offset:1024 sc1
buffer_load_dword v21, v22, s[16:19], s98 offen offset:3328 sc1
s_barrier
ds_read_b128 v[104:107], v12
ds_read_b128 v[108:111], v12 offset:1024
s_waitcnt lgkmcnt(1)
v_mfma_f32_32x32x16_bf16 v[224:239], v[96:99], v[104:107], v[64:79]
s_waitcnt lgkmcnt(0)
v_mfma_f32_32x32x16_bf16 v[240:255], v[100:103], v[108:111], v[64:79]
buffer_load_dwordx4 v[176:179], v1, s[16:19], s97 offen offset:0 sc1
s_nop 8
v_exp_f32 v224, v224
v_exp_f32 v225, v225
v_exp_f32 v226, v226
v_exp_f32 v227, v227
buffer_load_dwordx4 v[180:183], v1, s[16:19], s97 offen offset:2304 sc1
v_exp_f32 v228, v228
v_exp_f32 v229, v229
v_exp_f32 v230, v230
v_exp_f32 v231, v231
v_exp_f32 v232, v232
s_mov_b64 exec, s[100:101]
buffer_load_dwordx4 v[184:187], v3, s[16:19], s97 offen offset:0 sc1
s_mov_b64 exec, -1
v_cvt_pk_bf16_f32 v24, v224, v225
v_cvt_pk_bf16_f32 v25, v226, v227
v_cvt_pk_bf16_f32 v26, v228, v229
v_cvt_pk_bf16_f32 v27, v230, v231
v_exp_f32 v233, v233
v_exp_f32 v234, v234
v_mfma_f32_32x32x16_bf16 v[32:47], v[112:115], v[24:27], 0
s_mov_b64 exec, s[100:101]
buffer_load_dwordx4 v[188:191], v3, s[16:19], s97 offen offset:512 sc1
s_mov_b64 exec, -1
v_exp_f32 v235, v235
v_exp_f32 v236, v236
v_exp_f32 v237, v237
v_exp_f32 v238, v238
v_exp_f32 v239, v239
v_cvt_pk_bf16_f32 v28, v232, v233
v_cvt_pk_bf16_f32 v29, v234, v235
v_cvt_pk_bf16_f32 v30, v236, v237
v_cvt_pk_bf16_f32 v31, v238, v239
v_mfma_f32_32x32x16_bf16 v[224:239], v[96:99], v[108:111], 0
s_mov_b64 exec, s[100:101]
buffer_load_dwordx4 v[192:195], v3, s[16:19], s97 offen offset:2304 sc1
s_mov_b64 exec, -1
v_exp_f32 v240, v240
v_exp_f32 v241, v241
v_exp_f32 v242, v242
v_exp_f32 v243, v243
v_mfma_f32_32x32x16_bf16 v[32:47], v[116:119], v[28:31], v[32:47]
s_mov_b64 exec, s[100:101]
buffer_load_dwordx4 v[196:199], v3, s[16:19], s97 offen offset:2816 sc1
s_mov_b64 exec, -1
v_exp_f32 v244, v244
v_exp_f32 v245, v245
v_exp_f32 v246, v246
v_exp_f32 v247, v247
v_exp_f32 v248, v248
buffer_load_dword v8, v22, s[16:19], s97 offen offset:1024 sc1
v_cvt_pk_bf16_f32 v24, v240, v241
v_cvt_pk_bf16_f32 v25, v242, v243
v_cvt_pk_bf16_f32 v26, v244, v245
v_cvt_pk_bf16_f32 v27, v246, v247
v_exp_f32 v249, v249
v_exp_f32 v250, v250
v_mfma_f32_32x32x16_bf16 v[48:63], v[120:123], v[24:27], 0
buffer_load_dword v9, v22, s[16:19], s97 offen offset:3328 sc1
v_exp_f32 v251, v251
v_exp_f32 v252, v252
v_exp_f32 v253, v253
v_exp_f32 v254, v254
v_exp_f32 v255, v255
v_cvt_pk_bf16_f32 v28, v248, v249
v_cvt_pk_bf16_f32 v29, v250, v251
v_cvt_pk_bf16_f32 v30, v252, v253
v_cvt_pk_bf16_f32 v31, v254, v255
s_waitcnt vmcnt(16)
v_add3_u32 v16, s15, v128, v129
v_add3_u32 v17, v140, v141, v142
v_add3_u32 v16, v16, v130, v131
v_add3_u32 v17, v17, v143, v144
v_add3_u32 v16, v16, v132, v133
v_add3_u32 v17, v17, v145, v146
v_add3_u32 v16, v16, v134, v135
v_add3_u32 v17, v17, v147, v148
v_add3_u32 v16, v16, v136, v137
v_add3_u32 v17, v17, v149, v150
v_add3_u32 v16, v16, v138, v139
v_add_u32 v18, v4, v5
v_add3_u32 v16, v16, v17, v151
v_cmp_ne_u32 vcc, v16, v18
s_cbranch_vccnz L_hretry3
L_hok3:
v_mfma_f32_32x32x16_bf16 v[240:255], v[132:135], v[104:107], 0
buffer_load_dwordx4 v[200:203], v1, s[16:19], s96 offen offset:0 sc1
v_exp_f32 v224, v224
v_exp_f32 v225, v225
v_exp_f32 v226, v226
v_exp_f32 v227, v227
v_mfma_f32_32x32x16_bf16 v[48:63], v[124:127], v[28:31], v[48:63]
buffer_load_dwordx4 v[204:207], v1, s[16:19], s96 offen offset:2304 sc1
v_exp_f32 v228, v228
v_exp_f32 v229, v229
v_exp_f32 v230, v230
v_exp_f32 v231, v231
v_exp_f32 v232, v232
s_mov_b64 exec, s[100:101]
buffer_load_dwordx4 v[208:211], v3, s[16:19], s96 offen offset:0 sc1
s_mov_b64 exec, -1
v_cvt_pk_bf16_f32 v24, v224, v225
v_cvt_pk_bf16_f32 v25, v226, v227
v_cvt_pk_bf16_f32 v26, v228, v229
v_cvt_pk_bf16_f32 v27, v230, v231
v_exp_f32 v233, v233
v_exp_f32 v234, v234
v_mfma_f32_32x32x16_bf16 v[48:63], v[112:115], v[24:27], v[48:63]
s_mov_b64 exec, s[100:101]
buffer_load_dwordx4 v[212:215], v3, s[16:19], s96 offen offset:512 sc1
s_mov_b64 exec, -1
v_exp_f32 v235, v235
v_exp_f32 v236, v236
v_exp_f32 v237, v237
v_exp_f32 v238, v238
v_exp_f32 v239, v239
v_cvt_pk_bf16_f32 v28, v232, v233
v_cvt_pk_bf16_f32 v29, v234, v235
v_cvt_pk_bf16_f32 v30, v236, v237
v_cvt_pk_bf16_f32 v31, v238, v239
v_mfma_f32_32x32x16_bf16 v[224:239], v[132:135], v[108:111], 0
s_mov_b64 exec, s[100:101]
buffer_load_dwordx4 v[216:219], v3, s[16:19], s96 offen offset:2304 sc1
s_mov_b64 exec, -1
v_exp_f32 v240, v240
v_exp_f32 v241, v241
v_exp_f32 v242, v242
v_exp_f32 v243, v243
v_mfma_f32_32x32x16_bf16 v[48:63], v[116:119], v[28:31], v[48:63]
s_mov_b64 exec, s[100:101]
buffer_load_dwordx4 v[220:223], v3, s[16:19], s96 offen offset:2816 sc1
s_mov_b64 exec, -1
v_exp_f32 v244, v244
v_exp_f32 v245, v245
v_exp_f32 v246, v246
v_exp_f32 v247, v247
v_exp_f32 v248, v248
buffer_load_dword v6, v22, s[16:19], s96 offen offset:1024 sc1
v_cvt_pk_bf16_f32 v24, v240, v241
v_cvt_pk_bf16_f32 v25, v242, v243
v_cvt_pk_bf16_f32 v26, v244, v245
v_cvt_pk_bf16_f32 v27, v246, v247
v_exp_f32 v249, v249
v_exp_f32 v250, v250
v_mfma_f32_32x32x16_bf16 v[32:47], v[144:147], v[24:27], v[32:47]
buffer_load_dword v7, v22, s[16:19], s96 offen offset:3328 sc1
s_barrier
v_exp_f32 v251, v251
v_exp_f32 v252, v252
v_exp_f32 v253, v253
v_exp_f32 v254, v254
v_exp_f32 v255, v255
v_cvt_pk_bf16_f32 v28, v248, v249
v_cvt_pk_bf16_f32 v29, v250, v251
v_cvt_pk_bf16_f32 v30, v252, v253
v_cvt_pk_bf16_f32 v31, v254, v255
v_mfma_f32_32x32x16_bf16 v[240:255], v[128:131], v[104:107], 0
v_exp_f32 v224, v224
v_exp_f32 v225, v225
v_exp_f32 v226, v226
v_exp_f32 v227, v227
v_mfma_f32_32x32x16_bf16 v[32:47], v[148:151], v[28:31], v[32:47]
v_exp_f32 v228, v228
v_exp_f32 v229, v229
v_exp_f32 v230, v230
v_exp_f32 v231, v231
v_exp_f32 v232, v232
v_cvt_pk_bf16_f32 v24, v224, v225
v_cvt_pk_bf16_f32 v25, v226, v227
v_cvt_pk_bf16_f32 v26, v228, v229
v_cvt_pk_bf16_f32 v27, v230, v231
v_exp_f32 v233, v233
v_exp_f32 v234, v234
v_mfma_f32_32x32x16_bf16 v[48:63], v[144:147], v[24:27], v[48:63]
v_exp_f32 v235, v235
v_exp_f32 v236, v236
v_exp_f32 v237, v237
v_exp_f32 v238, v238
v_exp_f32 v239, v239
v_cvt_pk_bf16_f32 v28, v232, v233
v_cvt_pk_bf16_f32 v29, v234, v235
v_cvt_pk_bf16_f32 v30, v236, v237
v_cvt_pk_bf16_f32 v31, v238, v239
v_mfma_f32_32x32x16_bf16 v[224:239], v[128:131], v[108:111], 0
v_exp_f32 v240, v240
v_exp_f32 v241, v241
v_exp_f32 v242, v242
v_exp_f32 v243, v243
v_mfma_f32_32x32x16_bf16 v[48:63], v[148:151], v[28:31], v[48:63]
v_exp_f32 v244, v244
v_exp_f32 v245, v245
v_exp_f32 v246, v246
v_exp_f32 v247, v247
v_exp_f32 v248, v248
v_cvt_pk_bf16_f32 v24, v240, v241
v_cvt_pk_bf16_f32 v25, v242, v243
v_cvt_pk_bf16_f32 v26, v244, v245
v_cvt_pk_bf16_f32 v27, v246, v247
v_exp_f32 v249, v249
v_exp_f32 v250, v250
v_mfma_f32_32x32x16_bf16 v[32:47], v[136:139], v[24:27], v[32:47]
v_exp_f32 v251, v251
v_exp_f32 v252, v252
v_exp_f32 v253, v253
v_exp_f32 v254, v254
v_exp_f32 v255, v255
v_cvt_pk_bf16_f32 v28, v248, v249
v_cvt_pk_bf16_f32 v29, v250, v251
v_cvt_pk_bf16_f32 v30, v252, v253
v_cvt_pk_bf16_f32 v31, v254, v255
s_waitcnt vmcnt(16)
v_add3_u32 v16, s14, v152, v153
v_add3_u32 v17, v164, v165, v166
v_add3_u32 v16, v16, v154, v155
v_add3_u32 v17, v17, v167, v168
v_add3_u32 v16, v16, v156, v157
v_add3_u32 v17, v17, v169, v170
v_add3_u32 v16, v16, v158, v159
v_add3_u32 v17, v17, v171, v172
v_add3_u32 v16, v16, v160, v161
v_add3_u32 v17, v17, v173, v174
v_add3_u32 v16, v16, v162, v163
v_add_u32 v18, v20, v21
v_add3_u32 v16, v16, v17, v175
v_cmp_ne_u32 vcc, v16, v18
s_cbranch_vccnz L_hretry2
L_hok2:
v_mfma_f32_32x32x16_bf16 v[240:255], v[156:159], v[104:107], 0
v_exp_f32 v224, v224
v_exp_f32 v225, v225
v_exp_f32 v226, v226
v_exp_f32 v227, v227
v_mfma_f32_32x32x16_bf16 v[32:47], v[140:143], v[28:31], v[32:47]
v_exp_f32 v228, v228
v_exp_f32 v229, v229
v_exp_f32 v230, v230
v_exp_f32 v231, v231
v_exp_f32 v232, v232
v_cvt_pk_bf16_f32 v24, v224, v225
v_cvt_pk_bf16_f32 v25, v226, v227
v_cvt_pk_bf16_f32 v26, v228, v229
v_cvt_pk_bf16_f32 v27, v230, v231
v_exp_f32 v233, v233
v_exp_f32 v234, v234
v_mfma_f32_32x32x16_bf16 v[48:63], v[136:139], v[24:27], v[48:63]
v_exp_f32 v235, v235
v_exp_f32 v236, v236
v_exp_f32 v237, v237
v_exp_f32 v238, v238
v_exp_f32 v239, v239
v_cvt_pk_bf16_f32 v28, v232, v233
v_cvt_pk_bf16_f32 v29, v234, v235
v_cvt_pk_bf16_f32 v30, v236, v237
v_cvt_pk_bf16_f32 v31, v238, v239
v_mfma_f32_32x32x16_bf16 v[224:239], v[156:159], v[108:111], 0
v_exp_f32 v240, v240
v_exp_f32 v241, v241
v_exp_f32 v242, v242
v_exp_f32 v243, v243
v_mfma_f32_32x32x16_bf16 v[48:63], v[140:143], v[28:31], v[48:63]
v_exp_f32 v244, v244
v_exp_f32 v245, v245
v_exp_f32 v246, v246
v_exp_f32 v247, v247
v_exp_f32 v248, v248
v_cvt_pk_bf16_f32 v24, v240, v241
v_cvt_pk_bf16_f32 v25, v242, v243
v_cvt_pk_bf16_f32 v26, v244, v245
v_cvt_pk_bf16_f32 v27, v246, v247
v_exp_f32 v249, v249
v_exp_f32 v250, v250
v_mfma_f32_32x32x16_bf16 v[32:47], v[168:171], v[24:27], v[32:47]
v_exp_f32 v251, v251
v_exp_f32 v252, v252
v_exp_f32 v253, v253
v_exp_f32 v254, v254
v_exp_f32 v255, v255
v_cvt_pk_bf16_f32 v28, v248, v249
v_cvt_pk_bf16_f32 v29, v250, v251
v_cvt_pk_bf16_f32 v30, v252, v253
v_cvt_pk_bf16_f32 v31, v254, v255
v_mfma_f32_32x32x16_bf16 v[240:255], v[152:155], v[104:107], 0
v_exp_f32 v224, v224
v_exp_f32 v225, v225
v_exp_f32 v226, v226
v_exp_f32 v227, v227
v_mfma_f32_32x32x16_bf16 v[32:47], v[172:175], v[28:31], v[32:47]
v_exp_f32 v228, v228
v_exp_f32 v229, v229
v_exp_f32 v230, v230
v_exp_f32 v231, v231
v_exp_f32 v232, v232
v_cvt_pk_bf16_f32 v24, v224, v225
v_cvt_pk_bf16_f32 v25, v226, v227
v_cvt_pk_bf16_f32 v26, v228, v229
v_cvt_pk_bf16_f32 v27, v230, v231
v_exp_f32 v233, v233
v_exp_f32 v234, v234
v_mfma_f32_32x32x16_bf16 v[48:63], v[168:171], v[24:27], v[48:63]
v_exp_f32 v235, v235
v_exp_f32 v236, v236
v_exp_f32 v237, v237
v_exp_f32 v238, v238
v_exp_f32 v239, v239
v_cvt_pk_bf16_f32 v28, v232, v233
v_cvt_pk_bf16_f32 v29, v234, v235
v_cvt_pk_bf16_f32 v30, v236, v237
v_cvt_pk_bf16_f32 v31, v238, v239
v_mfma_f32_32x32x16_bf16 v[224:239], v[152:155], v[108:111], 0
v_exp_f32 v240, v240
v_exp_f32 v241, v241
v_exp_f32 v242, v242
v_exp_f32 v243, v243
v_mfma_f32_32x32x16_bf16 v[48:63], v[172:175], v[28:31], v[48:63]
v_exp_f32 v244, v244
v_exp_f32 v245, v245
v_exp_f32 v246, v246
v_exp_f32 v247, v247
v_exp_f32 v248, v248
v_cvt_pk_bf16_f32 v24, v240, v241
v_cvt_pk_bf16_f32 v25, v242, v243
v_cvt_pk_bf16_f32 v26, v244, v245
v_cvt_pk_bf16_f32 v27, v246, v247
v_exp_f32 v249, v249
v_exp_f32 v250, v250
v_mfma_f32_32x32x16_bf16 v[32:47], v[160:163], v[24:27], v[32:47]
v_exp_f32 v251, v251
v_exp_f32 v252, v252
v_exp_f32 v253, v253
v_exp_f32 v254, v254
v_exp_f32 v255, v255
v_cvt_pk_bf16_f32 v28, v248, v249
v_cvt_pk_bf16_f32 v29, v250, v251
v_cvt_pk_bf16_f32 v30, v252, v253
v_cvt_pk_bf16_f32 v31, v254, v255
s_waitcnt vmcnt(8)
v_add3_u32 v16, s13, v176, v177
v_add3_u32 v17, v188, v189, v190
v_add3_u32 v16, v16, v178, v179
v_add3_u32 v17, v17, v191, v192
v_add3_u32 v16, v16, v180, v181
v_add3_u32 v17, v17, v193, v194
v_add3_u32 v16, v16, v182, v183
v_add3_u32 v17, v17, v195, v196
v_add3_u32 v16, v16, v184, v185
v_add3_u32 v17, v17, v197, v198
v_add3_u32 v16, v16, v186, v187
v_add_u32 v18, v8, v9
v_add3_u32 v16, v16, v17, v199
v_cmp_ne_u32 vcc, v16, v18
s_cbranch_vccnz L_hretry1
L_hok1:
v_mfma_f32_32x32x16_bf16 v[240:255], v[180:183], v[104:107], 0
v_exp_f32 v224, v224
v_exp_f32 v225, v225
v_exp_f32 v226, v226
v_exp_f32 v227, v227
v_mfma_f32_32x32x16_bf16 v[32:47], v[164:167], v[28:31], v[32:47]
v_exp_f32 v228, v228
v_exp_f32 v229, v229
v_exp_f32 v230, v230
v_exp_f32 v231, v231
v_exp_f32 v232, v232
v_cvt_pk_bf16_f32 v24, v224, v225
v_cvt_pk_bf16_f32 v25, v226, v227
v_cvt_pk_bf16_f32 v26, v228, v229
v_cvt_pk_bf16_f32 v27, v230, v231
v_exp_f32 v233, v233
v_exp_f32 v234, v234
v_mfma_f32_32x32x16_bf16 v[48:63], v[160:163], v[24:27], v[48:63]
v_exp_f32 v235, v235
v_exp_f32 v236, v236
v_exp_f32 v237, v237
v_exp_f32 v238, v238
v_exp_f32 v239, v239
v_cvt_pk_bf16_f32 v28, v232, v233
v_cvt_pk_bf16_f32 v29, v234, v235
v_cvt_pk_bf16_f32 v30, v236, v237
v_cvt_pk_bf16_f32 v31, v238, v239
v_mfma_f32_32x32x16_bf16 v[224:239], v[180:183], v[108:111], 0
v_exp_f32 v240, v240
v_exp_f32 v241, v241
v_exp_f32 v242, v242
v_exp_f32 v243, v243
v_mfma_f32_32x32x16_bf16 v[48:63], v[164:167], v[28:31], v[48:63]
v_exp_f32 v244, v244
v_exp_f32 v245, v245
v_exp_f32 v246, v246
v_exp_f32 v247, v247
v_exp_f32 v248, v248
v_cvt_pk_bf16_f32 v24, v240, v241
v_cvt_pk_bf16_f32 v25, v242, v243
v_cvt_pk_bf16_f32 v26, v244, v245
v_cvt_pk_bf16_f32 v27, v246, v247
v_exp_f32 v249, v249
v_exp_f32 v250, v250
v_mfma_f32_32x32x16_bf16 v[32:47], v[192:195], v[24:27], v[32:47]
v_exp_f32 v251, v251
v_exp_f32 v252, v252
v_exp_f32 v253, v253
v_exp_f32 v254, v254
v_exp_f32 v255, v255
v_cvt_pk_bf16_f32 v28, v248, v249
v_cvt_pk_bf16_f32 v29, v250, v251
v_cvt_pk_bf16_f32 v30, v252, v253
v_cvt_pk_bf16_f32 v31, v254, v255
v_mfma_f32_32x32x16_bf16 v[240:255], v[176:179], v[104:107], 0
v_exp_f32 v224, v224
v_exp_f32 v225, v225
v_exp_f32 v226, v226
v_exp_f32 v227, v227
v_mfma_f32_32x32x16_bf16 v[32:47], v[196:199], v[28:31], v[32:47]
v_exp_f32 v228, v228
v_exp_f32 v229, v229
v_exp_f32 v230, v230
v_exp_f32 v231, v231
v_exp_f32 v232, v232
v_cvt_pk_bf16_f32 v24, v224, v225
v_cvt_pk_bf16_f32 v25, v226, v227
v_cvt_pk_bf16_f32 v26, v228, v229
v_cvt_pk_bf16_f32 v27, v230, v231
v_exp_f32 v233, v233
v_exp_f32 v234, v234
v_mfma_f32_32x32x16_bf16 v[48:63], v[192:195], v[24:27], v[48:63]
v_exp_f32 v235, v235
v_exp_f32 v236, v236
v_exp_f32 v237, v237
v_exp_f32 v238, v238
v_exp_f32 v239, v239
v_cvt_pk_bf16_f32 v28, v232, v233
v_cvt_pk_bf16_f32 v29, v234, v235
v_cvt_pk_bf16_f32 v30, v236, v237
v_cvt_pk_bf16_f32 v31, v238, v239
v_mfma_f32_32x32x16_bf16 v[224:239], v[176:179], v[108:111], 0
v_exp_f32 v240, v240
v_exp_f32 v241, v241
v_exp_f32 v242, v242
v_exp_f32 v243, v243
v_mfma_f32_32x32x16_bf16 v[48:63], v[196:199], v[28:31], v[48:63]
v_exp_f32 v244, v244
v_exp_f32 v245, v245
v_exp_f32 v246, v246
v_exp_f32 v247, v247
v_exp_f32 v248, v248
v_cvt_pk_bf16_f32 v24, v240, v241
v_cvt_pk_bf16_f32 v25, v242, v243
v_cvt_pk_bf16_f32 v26, v244, v245
v_cvt_pk_bf16_f32 v27, v246, v247
v_exp_f32 v249, v249
v_exp_f32 v250, v250
v_mfma_f32_32x32x16_bf16 v[32:47], v[184:187], v[24:27], v[32:47]
v_exp_f32 v251, v251
v_exp_f32 v252, v252
v_exp_f32 v253, v253
v_exp_f32 v254, v254
v_exp_f32 v255, v255
v_cvt_pk_bf16_f32 v28, v248, v249
v_cvt_pk_bf16_f32 v29, v250, v251
v_cvt_pk_bf16_f32 v30, v252, v253
v_cvt_pk_bf16_f32 v31, v254, v255
s_waitcnt vmcnt(0)
v_add3_u32 v16, s12, v200, v201
v_add3_u32 v17, v212, v213, v214
v_add3_u32 v16, v16, v202, v203
v_add3_u32 v17, v17, v215, v216
v_add3_u32 v16, v16, v204, v205
v_add3_u32 v17, v17, v217, v218
v_add3_u32 v16, v16, v206, v207
v_add3_u32 v17, v17, v219, v220
v_add3_u32 v16, v16, v208, v209
v_add3_u32 v17, v17, v221, v222
v_add3_u32 v16, v16, v210, v211
v_add_u32 v18, v6, v7
v_add3_u32 v16, v16, v17, v223
v_cmp_ne_u32 vcc, v16, v18
s_cbranch_vccnz L_hretry0
L_hok0:
v_mfma_f32_32x32x16_bf16 v[240:255], v[204:207], v[104:107], 0
v_exp_f32 v224, v224
v_exp_f32 v225, v225
v_exp_f32 v226, v226
v_exp_f32 v227, v227
v_mfma_f32_32x32x16_bf16 v[32:47], v[188:191], v[28:31], v[32:47]
v_exp_f32 v228, v228
v_exp_f32 v229, v229
v_exp_f32 v230, v230
v_exp_f32 v231, v231
v_exp_f32 v232, v232
v_cvt_pk_bf16_f32 v24, v224, v225
v_cvt_pk_bf16_f32 v25, v226, v227
v_cvt_pk_bf16_f32 v26, v228, v229
v_cvt_pk_bf16_f32 v27, v230, v231
v_exp_f32 v233, v233
v_exp_f32 v234, v234
v_mfma_f32_32x32x16_bf16 v[48:63], v[184:187], v[24:27], v[48:63]
v_exp_f32 v235, v235
v_exp_f32 v236, v236
v_exp_f32 v237, v237
v_exp_f32 v238, v238
v_exp_f32 v239, v239
v_cvt_pk_bf16_f32 v28, v232, v233
v_cvt_pk_bf16_f32 v29, v234, v235
v_cvt_pk_bf16_f32 v30, v236, v237
v_cvt_pk_bf16_f32 v31, v238, v239
v_mfma_f32_32x32x16_bf16 v[224:239], v[204:207], v[108:111], v[80:95]
v_exp_f32 v240, v240
v_exp_f32 v241, v241
v_exp_f32 v242, v242
v_exp_f32 v243, v243
v_mfma_f32_32x32x16_bf16 v[48:63], v[188:191], v[28:31], v[48:63]
v_exp_f32 v244, v244
v_exp_f32 v245, v245
v_exp_f32 v246, v246
v_exp_f32 v247, v247
v_exp_f32 v248, v248
v_cvt_pk_bf16_f32 v24, v240, v241
v_cvt_pk_bf16_f32 v25, v242, v243
v_cvt_pk_bf16_f32 v26, v244, v245
v_cvt_pk_bf16_f32 v27, v246, v247
v_exp_f32 v249, v249
v_exp_f32 v250, v250
v_mfma_f32_32x32x16_bf16 v[32:47], v[216:219], v[24:27], v[32:47]
v_exp_f32 v251, v251
v_exp_f32 v252, v252
v_exp_f32 v253, v253
v_exp_f32 v254, v254
v_exp_f32 v255, v255
v_cvt_pk_bf16_f32 v28, v248, v249
v_cvt_pk_bf16_f32 v29, v250, v251
v_cvt_pk_bf16_f32 v30, v252, v253
v_cvt_pk_bf16_f32 v31, v254, v255
v_mfma_f32_32x32x16_bf16 v[240:255], v[200:203], v[104:107], v[80:95]
v_exp_f32 v224, v224
v_exp_f32 v225, v225
v_exp_f32 v226, v226
v_exp_f32 v227, v227
v_mfma_f32_32x32x16_bf16 v[32:47], v[220:223], v[28:31], v[32:47]
v_exp_f32 v228, v228
v_exp_f32 v229, v229
v_exp_f32 v230, v230
v_exp_f32 v231, v231
v_exp_f32 v232, v232
v_cvt_pk_bf16_f32 v24, v224, v225
v_cvt_pk_bf16_f32 v25, v226, v227
v_cvt_pk_bf16_f32 v26, v228, v229
v_cvt_pk_bf16_f32 v27, v230, v231
v_exp_f32 v233, v233
v_exp_f32 v234, v234
v_mfma_f32_32x32x16_bf16 v[48:63], v[216:219], v[24:27], v[48:63]
v_exp_f32 v235, v235
v_exp_f32 v236, v236
v_exp_f32 v237, v237
v_exp_f32 v238, v238
v_exp_f32 v239, v239
v_cvt_pk_bf16_f32 v28, v232, v233
v_cvt_pk_bf16_f32 v29, v234, v235
v_cvt_pk_bf16_f32 v30, v236, v237
v_cvt_pk_bf16_f32 v31, v238, v239
v_exp_f32 v240, v240
v_exp_f32 v241, v241
v_exp_f32 v242, v242
v_exp_f32 v243, v243
v_mfma_f32_32x32x16_bf16 v[48:63], v[220:223], v[28:31], v[48:63]
v_exp_f32 v244, v244
v_exp_f32 v245, v245
v_exp_f32 v246, v246
v_exp_f32 v247, v247
v_exp_f32 v248, v248
v_cvt_pk_bf16_f32 v24, v240, v241
v_cvt_pk_bf16_f32 v25, v242, v243
v_cvt_pk_bf16_f32 v26, v244, v245
v_cvt_pk_bf16_f32 v27, v246, v247
v_exp_f32 v249, v249
v_exp_f32 v250, v250
v_mfma_f32_32x32x16_bf16 v[32:47], v[208:211], v[24:27], v[32:47]
v_exp_f32 v251, v251
v_exp_f32 v252, v252
v_exp_f32 v253, v253
v_exp_f32 v254, v254
v_exp_f32 v255, v255
v_cvt_pk_bf16_f32 v28, v248, v249
v_cvt_pk_bf16_f32 v29, v250, v251
v_cvt_pk_bf16_f32 v30, v252, v253
v_cvt_pk_bf16_f32 v31, v254, v255
s_nop 1
v_mfma_f32_32x32x16_bf16 v[32:47], v[212:215], v[28:31], v[32:47]
s_mov_b32 s60, 0x2b800000
v_subrev_u32 v4, s60, v56
v_rcp_f32 v6, v56
s_nop 0
v_pk_mul_f32 v[48:49], v[48:49], v[6:7] op_sel_hi:[1,0]
v_pk_mul_f32 v[50:51], v[50:51], v[6:7] op_sel_hi:[1,0]
v_pk_mul_f32 v[52:53], v[52:53], v[6:7] op_sel_hi:[1,0]
v_pk_mul_f32 v[54:55], v[54:55], v[6:7] op_sel_hi:[1,0]
v_cvt_pk_bf16_f32 v56, v48, v49
v_cvt_pk_bf16_f32 v57, v50, v51
v_cvt_pk_bf16_f32 v58, v52, v53
v_cvt_pk_bf16_f32 v59, v54, v55
v_add3_u32 v60, s6, v56, v57
v_add3_u32 v60, v60, v58, v59
v_subrev_u32 v5, s60, v40
v_max_u32 v4, v4, v5
v_cmp_lt_u32 vcc, 671088640, v4
s_cbranch_vccnz L_slow
L_attn_norm:
v_rcp_f32 v8, v40
buffer_store_dwordx4 v[56:59], v1, s[16:19], s64 offen sc1
buffer_store_dword v60, v22, s[16:19], s64 offen sc1
v_pk_mul_f32 v[32:33], v[32:33], v[8:9] op_sel_hi:[1,0]
v_pk_mul_f32 v[34:35], v[34:35], v[8:9] op_sel_hi:[1,0]
v_pk_mul_f32 v[36:37], v[36:37], v[8:9] op_sel_hi:[1,0]
v_pk_mul_f32 v[38:39], v[38:39], v[8:9] op_sel_hi:[1,0]
v_cvt_pk_bf16_f32 v40, v32, v33
v_cvt_pk_bf16_f32 v41, v34, v35
v_cvt_pk_bf16_f32 v42, v36, v37
v_cvt_pk_bf16_f32 v43, v38, v39
buffer_store_dwordx4 v[40:43], v1, s[16:19], s59 offen sc1
v_add3_u32 v44, s6, v40, v41
v_add3_u32 v44, v44, v42, v43
buffer_store_dword v44, v22, s[16:19], s59 offen sc1
v_mov_b32 v8, 151552
v_mov_b32 v9, 0
ds_write_b32 v8, v9
s_sleep 8
s_barrier
v_and_b32 v7, 15, v0
s_lshl_b32 s60, s3, 4
v_add_u32 v7, s60, v7
v_lshlrev_b32 v7, 4, v7
s_lshl_b32 s66, s6, 1
s_cmp_ge_u32 s65, 224
s_cbranch_scc1 L_down
s_lshl_b32 s62, s3, 12
s_add_u32 s62, s62, 131072
v_lshrrev_b32 v5, 4, v0
v_bfe_u32 v6, v0, 2, 2
v_lshl_add_u32 v6, v5, 5, v6
v_lshlrev_b32 v6, 4, v6
v_and_b32 v4, 1, v0
v_lshl_add_u32 v6, v4, 3, v6
v_and_b32 v4, 2, v0
v_lshl_add_u32 v6, v4, 10, v6
v_add_u32 v6, s62, v6
v_lshlrev_b32 v5, 8, v5
s_lshl_b32 s63, s3, 8
s_add_u32 s63, s63, 155648
v_lshl_add_u32 v4, v0, 2, s63
v_and_b32 v13, 7, v0
v_lshrrev_b32 v12, 3, v0
v_mul_u32_u24 v12, 14336, v12
v_lshl_add_u32 v12, v13, 3, v12
v_lshlrev_b32 v11, 2, v13
v_add_u32 v11, 151808, v11
s_lshl_b32 s63, s3, 6
s_add_u32 s63, s63, 151808
v_and_b32 v10, 48, v0
v_add_u32 v10, s63, v10
s_lshl_b32 s67, s65, 6
s_mul_i32 s63, s3, 114688
s_add_u32 s67, s67, s63
s_add_u32 s67, s67, 524288
v_mov_b32 v14, s6
s_lshr_b32 s63, s6, 12
v_mov_b32 v15, s63
s_waitcnt lgkmcnt(0)
s_barrier
s_barrier
s_barrier
s_barrier
s_lshl_b32 s61, s3, 10
s_add_u32 s61, s61, 262144
s_and_b32 s60, s2, 7
s_lshl_b32 s60, s60, 13
s_add_u32 s60, s60, 196608
ds_read2st64_b32 v[96:97], v4 offset0:0 offset1:4
ds_read2st64_b32 v[98:99], v4 offset0:8 offset1:12
ds_read2st64_b32 v[100:101], v4 offset0:16 offset1:20
ds_read2st64_b32 v[102:103], v4 offset0:24 offset1:28
s_waitcnt lgkmcnt(0)
v_lshlrev_b32 v80, 16, v96
v_and_b32 v81, 0xffff0000, v96
v_lshlrev_b32 v82, 16, v97
v_and_b32 v83, 0xffff0000, v97
v_lshlrev_b32 v84, 16, v98
v_and_b32 v85, 0xffff0000, v98
v_lshlrev_b32 v86, 16, v99
v_and_b32 v87, 0xffff0000, v99
v_lshlrev_b32 v88, 16, v100
v_and_b32 v89, 0xffff0000, v100
v_lshlrev_b32 v90, 16, v101
v_and_b32 v91, 0xffff0000, v101
v_lshlrev_b32 v92, 16, v102
v_and_b32 v93, 0xffff0000, v102
v_lshlrev_b32 v94, 16, v103
v_and_b32 v95, 0xffff0000, v103
s_sleep 12
s_movk_i32 s71, 20000
poll_3:
buffer_load_dwordx2 v[16:17], v7, s[16:19], s60 offen sc1
s_waitcnt vmcnt(0)
v_cmp_ne_u32 vcc, s6, v17
s_cbranch_vccz polld_4
s_sub_u32 s71, s71, 1
s_cbranch_scc1 polld_4
s_and_b32 vcc_lo, s71, 31
s_cbranch_scc1 poll_3
buffer_wbl2 sc1
s_branch poll_3
polld_4:
s_mov_b64 exec, 0xffff
ds_max_u32 v8, v16
s_mov_b64 exec, -1
s_waitcnt lgkmcnt(0)
s_barrier
ds_read_b32 v9, v8
s_waitcnt lgkmcnt(0)
v_readfirstlane_b32 s69, v9
s_andn2_b32 s70, 0x7ff, s69
s_lshr_b32 s60, s70, 5
s_lshl_b32 s60, s60, 12
s_add_u32 s60, s60, s61
L_rows:
buffer_load_dwordx4 v[48:51], v5, s[16:19], s60 offen offset:0 sc1
buffer_load_dwordx4 v[52:55], v5, s[16:19], s60 offen offset:16 sc1
buffer_load_dwordx4 v[56:59], v5, s[16:19], s60 offen offset:128 sc1
buffer_load_dwordx4 v[60:63], v5, s[16:19], s60 offen offset:144 sc1
buffer_load_dword v18, v5, s[16:19], s60 offen offset:32 sc1
buffer_load_dword v19, v5, s[16:19], s60 offen offset:160 sc1
ds_read_b64_tr_b16 v[32:33], v6 offset:0
ds_read_b64_tr_b16 v[34:35], v6 offset:64
ds_read_b64_tr_b16 v[36:37], v6 offset:128
ds_read_b64_tr_b16 v[38:39], v6 offset:192
ds_read_b64_tr_b16 v[40:41], v6 offset:256
ds_read_b64_tr_b16 v[42:43], v6 offset:320
ds_read_b64_tr_b16 v[44:45], v6 offset:384
ds_read_b64_tr_b16 v[46:47], v6 offset:448
s_waitcnt vmcnt(0) lgkmcnt(0)
v_mfma_f32_16x16x32_bf16 v[64:67], v[32:35], v[48:51], 0
v_mfma_f32_16x16x32_bf16 v[64:67], v[36:39], v[52:55], v[64:67]
v_mfma_f32_16x16x32_bf16 v[64:67], v[40:43], v[56:59], v[64:67]
v_mfma_f32_16x16x32_bf16 v[64:67], v[44:47], v[60:63], v[64:67]
v_add3_u32 v16, s66, v48, v49
v_add3_u32 v17, v56, v57, v58
v_add3_u32 v16, v16, v50, v51
v_add3_u32 v17, v17, v59, v60
v_add3_u32 v16, v16, v52, v53
v_add3_u32 v17, v17, v61, v62
v_add3_u32 v16, v16, v54, v55
v_add_u32 v18, v18, v19
v_add3_u32 v16, v16, v17, v63
v_cmp_ne_u32 vcc, v16, v18
s_cbranch_vccnz L_rretry
L_rok:
s_mov_b32 exec_lo, 0x00010001
s_mov_b32 exec_hi, 0x00010001
ds_write_b128 v10, v[64:67]
s_mov_b64 exec, -1
s_waitcnt lgkmcnt(0)
s_barrier
ds_read2_b32 v[16:17], v11 offset0:0 offset1:8
ds_read2_b32 v[18:19], v11 offset0:16 offset1:24
ds_read2_b32 v[20:21], v11 offset0:32 offset1:40
ds_read2_b32 v[22:23], v11 offset0:48 offset1:56
s_movk_i32 s63, 0xfff
s_waitcnt lgkmcnt(2)
v_pk_add_f32 v[16:17], v[16:17], v[18:19]
s_waitcnt lgkmcnt(0)
v_pk_add_f32 v[20:21], v[20:21], v[22:23]
v_pk_add_f32 v[16:17], v[16:17], v[20:21]
v_cvt_pk_bf16_f32 v20, v16, v17
v_lshlrev_b32 v16, 16, v20
v_mul_f32 v22, 0xbfb8aa3b, v16
v_exp_f32 v22, v22
v_and_b32 v17, 0xffff0000, v20
v_add_f32 v22, 1.0, v22
v_rcp_f32 v22, v22
s_nop 0
v_mul_f32 v16, v16, v22
v_cvt_pk_bf16_f32 v16, v16, v16
v_and_b32 v16, 0xffff0000, v16
v_mul_f32 v16, v16, v17
v_cvt_pk_bf16_f32 v16, v16, v16
v_and_b32 v16, 0xffff0000, v16
s_nop 1
v_mul_f32_dpp v18, v16, v80 row_newbcast:0 row_mask:0xf bank_mask:0xf
v_mul_f32_dpp v19, v16, v81 row_newbcast:0 row_mask:0xf bank_mask:0xf
v_mul_f32_dpp v20, v16, v82 row_newbcast:1 row_mask:0xf bank_mask:0xf
v_mul_f32_dpp v21, v16, v83 row_newbcast:1 row_mask:0xf bank_mask:0xf
v_fmac_f32_dpp v18, v16, v84 row_newbcast:2 row_mask:0xf bank_mask:0xf
v_fmac_f32_dpp v19, v16, v85 row_newbcast:2 row_mask:0xf bank_mask:0xf
v_fmac_f32_dpp v20, v16, v86 row_newbcast:3 row_mask:0xf bank_mask:0xf
v_fmac_f32_dpp v21, v16, v87 row_newbcast:3 row_mask:0xf bank_mask:0xf
v_fmac_f32_dpp v18, v16, v88 row_newbcast:4 row_mask:0xf bank_mask:0xf
v_fmac_f32_dpp v19, v16, v89 row_newbcast:4 row_mask:0xf bank_mask:0xf
v_fmac_f32_dpp v20, v16, v90 row_newbcast:5 row_mask:0xf bank_mask:0xf
v_fmac_f32_dpp v21, v16, v91 row_newbcast:5 row_mask:0xf bank_mask:0xf
v_fmac_f32_dpp v18, v16, v92 row_newbcast:6 row_mask:0xf bank_mask:0xf
v_fmac_f32_dpp v19, v16, v93 row_newbcast:6 row_mask:0xf bank_mask:0xf
v_fmac_f32_dpp v20, v16, v94 row_newbcast:7 row_mask:0xf bank_mask:0xf
v_fmac_f32_dpp v21, v16, v95 row_newbcast:7 row_mask:0xf bank_mask:0xf
v_pk_add_f32 v[18:19], v[18:19], v[20:21]
v_bfi_b32 v18, s63, v14, v18
v_bfi_b32 v19, s63, v15, v19
buffer_store_dwordx2 v[18:19], v12, s[16:19], s67 offen sc1
s_barrier
s_branch L_cend
L_down:
s_sub_u32 s65, s65, 224
s_mul_i32 s67, s3, 3584
s_mul_i32 s61, s65, 14336
s_add_u32 s67, s67, s61
s_add_u32 s12, s67, 524288
s_add_u32 s13, s12, 1024
s_add_u32 s14, s12, 2048
s_add_u32 s15, s12, 3072
v_lshrrev_b32 v4, 2, v0
v_and_b32 v5, 3, v0
v_lshlrev_b32 v5, 4, v5
v_lshl_add_u32 v4, v4, 6, v5
s_lshr_b32 s68, s6, 12
s_and_b32 s61, s6, 0xfff
s_and_b32 s62, s68, 0xfff
v_mov_b32 v52, s61
v_mov_b32 v53, s62
v_mov_b32 v54, s61
v_mov_b32 v55, s62

v_and_b32 v14, 7, v0
v_lshlrev_b32 v14, 2, v14
v_and_b32 v10, 3, v0
v_lshlrev_b32 v10, 4, v10
v_bfe_u32 v11, v0, 4, 1
v_lshl_add_u32 v10, v11, 3, v10
v_lshrrev_b32 v11, 5, v0
v_lshl_add_u32 v10, v11, 2, v10
s_lshl_b32 s61, s3, 6
s_add_u32 s61, s61, 151808
v_add_u32 v10, s61, v10
v_lshlrev_b32 v11, 3, v0
v_add_u32 v11, 151808, v11
s_lshl_b32 s61, s65, 7
s_add_u32 s61, s61, 262144
s_lshl_b32 s65, s65, 5
s_waitcnt lgkmcnt(0)
s_barrier
s_barrier
s_barrier
s_barrier
s_mov_b32 s64, 0xfffff000
s_and_b32 s60, s2, 7
s_lshl_b32 s60, s60, 13
s_add_u32 s60, s60, 196608
s_sleep 12
s_movk_i32 s71, 20000
poll_5:
buffer_load_dwordx2 v[16:17], v7, s[16:19], s60 offen sc1
s_waitcnt vmcnt(0)
v_cmp_ne_u32 vcc, s6, v17
s_cbranch_vccz polld_6
s_sub_u32 s71, s71, 1
s_cbranch_scc1 polld_6
s_and_b32 vcc_lo, s71, 31
s_cbranch_scc1 poll_5
buffer_wbl2 sc1
s_branch poll_5
polld_6:
s_mov_b64 exec, 0xffff
ds_max_u32 v8, v16
s_mov_b64 exec, -1
s_waitcnt lgkmcnt(0)
s_barrier
ds_read_b32 v9, v8
s_waitcnt lgkmcnt(0)
v_readfirstlane_b32 s69, v9
s_andn2_b32 s70, 0x7ff, s69
s_lshr_b32 s60, s70, 5
s_lshl_b32 s60, s60, 12
s_add_u32 s60, s60, s61
s_movk_i32 s71, 20000
poll_7:
buffer_load_dword v32, v14, s[16:19], s60 offen sc1
buffer_load_dword v33, v14, s[16:19], s60 offen offset:48 sc1
buffer_load_dwordx2 v[18:19], off, s[16:19], s60 offset:32 sc1
s_waitcnt vmcnt(0)
v_add_u32 v16, v32, v33
v_add_u32 v18, v18, v19
s_nop 0
v_add_u32_dpp v16, v16, v16 quad_perm:[1,0,3,2] row_mask:0xf bank_mask:0xf
s_nop 1
v_add_u32_dpp v16, v16, v16 quad_perm:[2,3,0,1] row_mask:0xf bank_mask:0xf
s_nop 1
v_add_u32_dpp v16, v16, v16 row_half_mirror row_mask:0xf bank_mask:0xf
v_add_u32 v16, s66, v16
v_cmp_ne_u32 vcc, v16, v18
s_cbranch_vccz polld_8
s_sub_u32 s71, s71, 1
s_cbranch_scc0 poll_7
polld_8:
s_or_b32 s61, s65, s3
s_cbranch_scc1 L_ep
s_mov_b64 exec, 1
v_mov_b32 v20, s6
buffer_store_dword v20, off, s[16:19], 0 sc1
s_mov_b64 exec, -1
L_ep:
s_and_b32 s61, s69, 0xfffff800
s_not_b32 s62, s61
s_xor_b32 s63, s61, 0x80000000
s_cmp_ge_u32 s61, 0x80000000
s_cselect_b32 s61, s63, s62
v_mov_b32 v34, s61
v_cvt_pk_bf16_f32 v34, v34, v34
v_and_b32 v34, 0xffff0000, v34
v_mul_f32 v34, 0xbfb8aa3b, v34
v_exp_f32 v34, v34
s_nop 0
v_add_f32 v34, 1.0, v34
v_rcp_f32 v34, v34
s_nop 0
v_cvt_pk_bf16_f32 v34, v34, v34
v_and_b32 v34, 0xffff0000, v34
v_lshlrev_b32 v36, 16, v32
v_and_b32 v37, 0xffff0000, v32
v_lshlrev_b32 v38, 16, v33
v_and_b32 v39, 0xffff0000, v33
s_sleep 24
s_movk_i32 s71, 20000
s_mov_b64 s[96:97], -1
s_mov_b64 s[98:99], -1
s_mov_b64 s[100:101], -1
s_mov_b64 s[8:9], 0xffffffff
s_mov_b64 exec, s[96:97]
buffer_load_dwordx4 v[40:43], v4, s[16:19], s12 offen sc1
s_mov_b64 exec, s[98:99]
buffer_load_dwordx4 v[44:47], v4, s[16:19], s13 offen sc1
s_mov_b64 exec, s[100:101]
buffer_load_dwordx4 v[48:51], v4, s[16:19], s14 offen sc1
s_mov_b64 exec, s[8:9]
buffer_load_dwordx4 v[52:55], v4, s[16:19], s15 offen sc1
s_mov_b64 exec, -1
s_sleep 6
L_pm:
s_mov_b64 exec, s[96:97]
buffer_load_dwordx4 v[40:43], v4, s[16:19], s12 offen sc1
s_mov_b64 exec, s[98:99]
buffer_load_dwordx4 v[44:47], v4, s[16:19], s13 offen sc1
s_mov_b64 exec, s[100:101]
buffer_load_dwordx4 v[48:51], v4, s[16:19], s14 offen sc1
s_mov_b64 exec, s[8:9]
buffer_load_dwordx4 v[52:55], v4, s[16:19], s15 offen sc1
s_mov_b64 exec, -1
s_waitcnt vmcnt(4)
v_bitop3_b32 v16, v40, v42, s6 bitop3:0x7e
v_bitop3_b32 v17, v41, v43, s68 bitop3:0x7e
v_bitop3_b32 v18, v44, v46, s6 bitop3:0x7e
v_bitop3_b32 v19, v45, v47, s68 bitop3:0x7e
v_bitop3_b32 v20, v48, v50, s6 bitop3:0x7e
v_bitop3_b32 v21, v49, v51, s68 bitop3:0x7e
v_bitop3_b32 v22, v52, v54, s6 bitop3:0x7e
v_bitop3_b32 v23, v53, v55, s68 bitop3:0x7e
v_bitop3_b32 v16, v16, v17, s64 bitop3:0x54
v_bitop3_b32 v18, v18, v19, s64 bitop3:0x54
v_bitop3_b32 v20, v20, v21, s64 bitop3:0x54
v_bitop3_b32 v22, v22, v23, s64 bitop3:0x54
v_cmp_ne_u32 s[96:97], 0, v16
v_cmp_ne_u32 s[98:99], 0, v18
v_cmp_ne_u32 s[100:101], 0, v20
v_cmp_ne_u32 s[8:9], 0, v22
s_or_b64 s[10:11], s[96:97], s[98:99]
s_or_b64 s[10:11], s[10:11], s[100:101]
s_or_b64 s[10:11], s[10:11], s[8:9]
s_cbranch_scc0 L_pmd
s_or_b32 s96, s96, 1
s_or_b32 s98, s98, 1
s_or_b32 s100, s100, 1
s_or_b32 s8, s8, 1
s_sub_u32 s71, s71, 1
s_cbranch_scc0 L_pm
L_pmd:
v_and_b32 v104, s64, v40
v_and_b32 v105, s64, v41
v_and_b32 v106, s64, v42
v_and_b32 v107, s64, v43
v_and_b32 v108, s64, v44
v_and_b32 v109, s64, v45
v_and_b32 v110, s64, v46
v_and_b32 v111, s64, v47
v_and_b32 v112, s64, v48
v_and_b32 v113, s64, v49
v_and_b32 v114, s64, v50
v_and_b32 v115, s64, v51
v_and_b32 v116, s64, v52
v_and_b32 v117, s64, v53
v_and_b32 v118, s64, v54
v_and_b32 v119, s64, v55
v_pk_add_f32 v[104:105], v[104:105], v[108:109]
v_pk_add_f32 v[106:107], v[106:107], v[110:111]
v_pk_add_f32 v[112:113], v[112:113], v[116:117]
v_pk_add_f32 v[114:115], v[114:115], v[118:119]
v_pk_add_f32 v[104:105], v[104:105], v[112:113]
v_pk_add_f32 v[106:107], v[106:107], v[114:115]
s_nop 0
v_permlane32_swap_b32 v104, v105
v_permlane32_swap_b32 v106, v107
v_add_f32 v104, v104, v105
v_add_f32 v106, v106, v107
s_nop 1
v_permlane16_swap_b32 v104, v106
v_add_f32 v104, v104, v106
s_nop 1
v_add_f32_dpp v104, v104, v104 row_ror:4 row_mask:0xf bank_mask:0xf
s_nop 1
v_add_f32_dpp v104, v104, v104 row_ror:8 row_mask:0xf bank_mask:0xf
ds_write_b32 v10, v104
s_waitcnt lgkmcnt(0)
s_barrier
s_cmp_lg_u32 s3, 0
s_cbranch_scc1 L_dn_other
s_mov_b64 exec, 0xff
ds_read2_b64 v[16:19], v11 offset0:0 offset1:8
ds_read2_b64 v[20:23], v11 offset0:16 offset1:24
s_lshl_b32 s60, s70, 10
s_add_u32 s60, s60, s65
s_waitcnt lgkmcnt(0)
v_pk_add_f32 v[16:17], v[16:17], v[18:19]
v_pk_add_f32 v[20:21], v[20:21], v[22:23]
v_pk_add_f32 v[16:17], v[16:17], v[20:21]
v_cvt_pk_bf16_f32 v20, v16, v17
v_lshlrev_b32 v16, 16, v20
v_and_b32 v17, 0xffff0000, v20
v_pk_mul_f32 v[16:17], v[16:17], v[34:35] op_sel_hi:[1,0]
v_cvt_pk_bf16_f32 v20, v16, v17
v_lshlrev_b32 v16, 16, v20
v_and_b32 v17, 0xffff0000, v20
v_pk_add_f32 v[16:17], v[16:17], v[36:37]
v_cvt_pk_bf16_f32 v20, v16, v17
v_lshlrev_b32 v16, 16, v20
v_and_b32 v17, 0xffff0000, v20
v_pk_add_f32 v[16:17], v[16:17], v[38:39]
v_cvt_pk_bf16_f32 v20, v16, v17
buffer_store_dword v20, v14, s[24:27], s60 offen sc1

L_dn_other:
s_mov_b64 exec, -1
L_cend:
s_endpgm
L_oretry:
s_movk_i32 s71, 20000
poll_1001:
s_sleep 3
v_add3_u32 v40, s6, v96, v97
v_add3_u32 v40, v40, v98, v99
v_cmp_ne_u32 vcc, v40, v32
s_cbranch_vccz L_osk0
buffer_load_dwordx4 v[96:99], v5, s[16:19], s8 offen sc1
buffer_load_dword v32, v3, s[16:19], s8 offen sc1
L_osk0:
v_add3_u32 v40, s6, v100, v101
v_add3_u32 v40, v40, v102, v103
v_cmp_ne_u32 vcc, v40, v33
s_cbranch_vccz L_osk1
buffer_load_dwordx4 v[100:103], v5, s[16:19], s9 offen sc1
buffer_load_dword v33, v3, s[16:19], s9 offen sc1
L_osk1:
v_add3_u32 v40, s6, v104, v105
v_add3_u32 v40, v40, v106, v107
v_cmp_ne_u32 vcc, v40, v34
s_cbranch_vccz L_osk2
buffer_load_dwordx4 v[104:107], v5, s[16:19], s10 offen sc1
buffer_load_dword v34, v3, s[16:19], s10 offen sc1
L_osk2:
v_add3_u32 v40, s6, v108, v109
v_add3_u32 v40, v40, v110, v111
v_cmp_ne_u32 vcc, v40, v35
s_cbranch_vccz L_osk3
buffer_load_dwordx4 v[108:111], v5, s[16:19], s11 offen sc1
buffer_load_dword v35, v3, s[16:19], s11 offen sc1
L_osk3:
v_add3_u32 v40, s6, v112, v113
v_add3_u32 v40, v40, v114, v115
v_cmp_ne_u32 vcc, v40, v36
s_cbranch_vccz L_osk4
buffer_load_dwordx4 v[112:115], v5, s[16:19], s12 offen sc1
buffer_load_dword v36, v3, s[16:19], s12 offen sc1
L_osk4:
v_add3_u32 v40, s6, v116, v117
v_add3_u32 v40, v40, v118, v119
v_cmp_ne_u32 vcc, v40, v37
s_cbranch_vccz L_osk5
buffer_load_dwordx4 v[116:119], v5, s[16:19], s13 offen sc1
buffer_load_dword v37, v3, s[16:19], s13 offen sc1
L_osk5:
v_add3_u32 v40, s6, v120, v121
v_add3_u32 v40, v40, v122, v123
v_cmp_ne_u32 vcc, v40, v38
s_cbranch_vccz L_osk6
buffer_load_dwordx4 v[120:123], v5, s[16:19], s14 offen sc1
buffer_load_dword v38, v3, s[16:19], s14 offen sc1
L_osk6:
v_add3_u32 v40, s6, v124, v125
v_add3_u32 v40, v40, v126, v127
v_cmp_ne_u32 vcc, v40, v39
s_cbranch_vccz L_osk7
buffer_load_dwordx4 v[124:127], v5, s[16:19], s15 offen sc1
buffer_load_dword v39, v3, s[16:19], s15 offen sc1
L_osk7:
s_waitcnt vmcnt(0)
ds_write_b128 v72, v[96:99] offset:0
ds_write_b128 v72, v[100:103] offset:1024
ds_write_b128 v72, v[104:107] offset:2048
ds_write_b128 v72, v[108:111] offset:3072
ds_write_b128 v72, v[112:115] offset:4096
ds_write_b128 v72, v[116:119] offset:5120
ds_write_b128 v72, v[120:123] offset:6144
ds_write_b128 v72, v[124:127] offset:7168
v_add3_u32 v40, s67, v96, v97
v_add3_u32 v41, v112, v113, v114
v_add3_u32 v42, v32, v33, v34
v_add3_u32 v40, v40, v98, v99
v_add3_u32 v41, v41, v115, v116
v_add3_u32 v42, v42, v35, v36
v_add3_u32 v40, v40, v100, v101
v_add3_u32 v41, v41, v117, v118
v_add3_u32 v42, v42, v37, v38
v_add3_u32 v40, v40, v102, v103
v_add3_u32 v41, v41, v119, v120
v_add_u32 v42, v42, v39
v_add3_u32 v40, v40, v104, v105
v_add3_u32 v41, v41, v121, v122
v_add3_u32 v40, v40, v106, v107
v_add3_u32 v41, v41, v123, v124
v_add3_u32 v40, v40, v108, v109
v_add3_u32 v41, v41, v125, v126
v_add3_u32 v40, v40, v110, v111
v_add_u32 v41, v41, v127
v_add_u32 v40, v40, v41
v_cmp_ne_u32 vcc, v40, v42
s_cbranch_vccz polld_1002
s_sub_u32 s71, s71, 1
s_cbranch_scc1 polld_1002
s_and_b32 vcc_lo, s71, 31
s_cbranch_scc1 poll_1001
buffer_wbl2 sc1
s_branch poll_1001
polld_1002:
s_branch L_ook
L_hretry3:
s_movk_i32 s71, 20000
poll_1003:
buffer_load_dwordx4 v[128:131], v1, s[16:19], s99 offen offset:0 sc1
buffer_load_dwordx4 v[132:135], v1, s[16:19], s99 offen offset:2304 sc1
s_mov_b64 exec, s[100:101]
buffer_load_dwordx4 v[136:139], v3, s[16:19], s99 offen offset:0 sc1
buffer_load_dwordx4 v[140:143], v3, s[16:19], s99 offen offset:512 sc1
buffer_load_dwordx4 v[144:147], v3, s[16:19], s99 offen offset:2304 sc1
buffer_load_dwordx4 v[148:151], v3, s[16:19], s99 offen offset:2816 sc1
s_mov_b64 exec, -1
buffer_load_dword v4, v22, s[16:19], s99 offen offset:1024 sc1
buffer_load_dword v5, v22, s[16:19], s99 offen offset:3328 sc1
s_waitcnt vmcnt(0)
v_add3_u32 v16, s15, v128, v129
v_add3_u32 v17, v140, v141, v142
v_add3_u32 v16, v16, v130, v131
v_add3_u32 v17, v17, v143, v144
v_add3_u32 v16, v16, v132, v133
v_add3_u32 v17, v17, v145, v146
v_add3_u32 v16, v16, v134, v135
v_add3_u32 v17, v17, v147, v148
v_add3_u32 v16, v16, v136, v137
v_add3_u32 v17, v17, v149, v150
v_add3_u32 v16, v16, v138, v139
v_add_u32 v18, v4, v5
v_add3_u32 v16, v16, v17, v151
v_cmp_ne_u32 vcc, v16, v18
s_cbranch_vccz polld_1004
s_sub_u32 s71, s71, 1
s_cbranch_scc1 polld_1004
s_and_b32 vcc_lo, s71, 31
s_cbranch_scc1 poll_1003
buffer_wbl2 sc1
s_branch poll_1003
polld_1004:
s_branch L_hok3
L_hretry2:
s_movk_i32 s71, 20000
poll_1005:
buffer_load_dwordx4 v[152:155], v1, s[16:19], s98 offen offset:0 sc1
buffer_load_dwordx4 v[156:159], v1, s[16:19], s98 offen offset:2304 sc1
s_mov_b64 exec, s[100:101]
buffer_load_dwordx4 v[160:163], v3, s[16:19], s98 offen offset:0 sc1
buffer_load_dwordx4 v[164:167], v3, s[16:19], s98 offen offset:512 sc1
buffer_load_dwordx4 v[168:171], v3, s[16:19], s98 offen offset:2304 sc1
buffer_load_dwordx4 v[172:175], v3, s[16:19], s98 offen offset:2816 sc1
s_mov_b64 exec, -1
buffer_load_dword v20, v22, s[16:19], s98 offen offset:1024 sc1
buffer_load_dword v21, v22, s[16:19], s98 offen offset:3328 sc1
s_waitcnt vmcnt(0)
v_add3_u32 v16, s14, v152, v153
v_add3_u32 v17, v164, v165, v166
v_add3_u32 v16, v16, v154, v155
v_add3_u32 v17, v17, v167, v168
v_add3_u32 v16, v16, v156, v157
v_add3_u32 v17, v17, v169, v170
v_add3_u32 v16, v16, v158, v159
v_add3_u32 v17, v17, v171, v172
v_add3_u32 v16, v16, v160, v161
v_add3_u32 v17, v17, v173, v174
v_add3_u32 v16, v16, v162, v163
v_add_u32 v18, v20, v21
v_add3_u32 v16, v16, v17, v175
v_cmp_ne_u32 vcc, v16, v18
s_cbranch_vccz polld_1006
s_sub_u32 s71, s71, 1
s_cbranch_scc1 polld_1006
s_and_b32 vcc_lo, s71, 31
s_cbranch_scc1 poll_1005
buffer_wbl2 sc1
s_branch poll_1005
polld_1006:
s_branch L_hok2
L_hretry1:
s_movk_i32 s71, 20000
poll_1007:
buffer_load_dwordx4 v[176:179], v1, s[16:19], s97 offen offset:0 sc1
buffer_load_dwordx4 v[180:183], v1, s[16:19], s97 offen offset:2304 sc1
s_mov_b64 exec, s[100:101]
buffer_load_dwordx4 v[184:187], v3, s[16:19], s97 offen offset:0 sc1
buffer_load_dwordx4 v[188:191], v3, s[16:19], s97 offen offset:512 sc1
buffer_load_dwordx4 v[192:195], v3, s[16:19], s97 offen offset:2304 sc1
buffer_load_dwordx4 v[196:199], v3, s[16:19], s97 offen offset:2816 sc1
s_mov_b64 exec, -1
buffer_load_dword v8, v22, s[16:19], s97 offen offset:1024 sc1
buffer_load_dword v9, v22, s[16:19], s97 offen offset:3328 sc1
s_waitcnt vmcnt(0)
v_add3_u32 v16, s13, v176, v177
v_add3_u32 v17, v188, v189, v190
v_add3_u32 v16, v16, v178, v179
v_add3_u32 v17, v17, v191, v192
v_add3_u32 v16, v16, v180, v181
v_add3_u32 v17, v17, v193, v194
v_add3_u32 v16, v16, v182, v183
v_add3_u32 v17, v17, v195, v196
v_add3_u32 v16, v16, v184, v185
v_add3_u32 v17, v17, v197, v198
v_add3_u32 v16, v16, v186, v187
v_add_u32 v18, v8, v9
v_add3_u32 v16, v16, v17, v199
v_cmp_ne_u32 vcc, v16, v18
s_cbranch_vccz polld_1008
s_sub_u32 s71, s71, 1
s_cbranch_scc1 polld_1008
s_and_b32 vcc_lo, s71, 31
s_cbranch_scc1 poll_1007
buffer_wbl2 sc1
s_branch poll_1007
polld_1008:
s_branch L_hok1
L_hretry0:
s_movk_i32 s71, 20000
poll_1009:
buffer_load_dwordx4 v[200:203], v1, s[16:19], s96 offen offset:0 sc1
buffer_load_dwordx4 v[204:207], v1, s[16:19], s96 offen offset:2304 sc1
s_mov_b64 exec, s[100:101]
buffer_load_dwordx4 v[208:211], v3, s[16:19], s96 offen offset:0 sc1
buffer_load_dwordx4 v[212:215], v3, s[16:19], s96 offen offset:512 sc1
buffer_load_dwordx4 v[216:219], v3, s[16:19], s96 offen offset:2304 sc1
buffer_load_dwordx4 v[220:223], v3, s[16:19], s96 offen offset:2816 sc1
s_mov_b64 exec, -1
buffer_load_dword v6, v22, s[16:19], s96 offen offset:1024 sc1
buffer_load_dword v7, v22, s[16:19], s96 offen offset:3328 sc1
s_waitcnt vmcnt(0)
v_add3_u32 v16, s12, v200, v201
v_add3_u32 v17, v212, v213, v214
v_add3_u32 v16, v16, v202, v203
v_add3_u32 v17, v17, v215, v216
v_add3_u32 v16, v16, v204, v205
v_add3_u32 v17, v17, v217, v218
v_add3_u32 v16, v16, v206, v207
v_add3_u32 v17, v17, v219, v220
v_add3_u32 v16, v16, v208, v209
v_add3_u32 v17, v17, v221, v222
v_add3_u32 v16, v16, v210, v211
v_add_u32 v18, v6, v7
v_add3_u32 v16, v16, v17, v223
v_cmp_ne_u32 vcc, v16, v18
s_cbranch_vccz polld_1010
s_sub_u32 s71, s71, 1
s_cbranch_scc1 polld_1010
s_and_b32 vcc_lo, s71, 31
s_cbranch_scc1 poll_1009
buffer_wbl2 sc1
s_branch poll_1009
polld_1010:
s_branch L_hok0
L_rretry:
s_movk_i32 s71, 20000
poll_1011:
buffer_load_dwordx4 v[48:51], v5, s[16:19], s60 offen offset:0 sc1
buffer_load_dwordx4 v[52:55], v5, s[16:19], s60 offen offset:16 sc1
buffer_load_dwordx4 v[56:59], v5, s[16:19], s60 offen offset:128 sc1
buffer_load_dwordx4 v[60:63], v5, s[16:19], s60 offen offset:144 sc1
buffer_load_dword v18, v5, s[16:19], s60 offen offset:32 sc1
buffer_load_dword v19, v5, s[16:19], s60 offen offset:160 sc1
s_waitcnt vmcnt(0)
v_add3_u32 v16, s66, v48, v49
v_add3_u32 v17, v56, v57, v58
v_add3_u32 v16, v16, v50, v51
v_add3_u32 v17, v17, v59, v60
v_add3_u32 v16, v16, v52, v53
v_add3_u32 v17, v17, v61, v62
v_add3_u32 v16, v16, v54, v55
v_add_u32 v18, v18, v19
v_add3_u32 v16, v16, v17, v63
v_cmp_ne_u32 vcc, v16, v18
s_cbranch_vccz polld_1012
s_sub_u32 s71, s71, 1
s_cbranch_scc0 poll_1011
polld_1012:
v_mfma_f32_16x16x32_bf16 v[64:67], v[32:35], v[48:51], 0
v_mfma_f32_16x16x32_bf16 v[64:67], v[36:39], v[52:55], v[64:67]
v_mfma_f32_16x16x32_bf16 v[64:67], v[40:43], v[56:59], v[64:67]
v_mfma_f32_16x16x32_bf16 v[64:67], v[44:47], v[60:63], v[64:67]
s_nop 7
s_branch L_rok
L_cold:
L_slow:
s_nop 15
v_mov_b32 v4, 0xff800000
v_mov_b32 v5, 0xff800000
v_mfma_f32_32x32x16_bf16 v[224:239], v[96:99], v[104:107], v[64:79]
s_nop 11
v_max3_f32 v4, v4, v224, v225
v_max3_f32 v4, v4, v226, v227
v_max3_f32 v4, v4, v228, v229
v_max3_f32 v4, v4, v230, v231
v_max3_f32 v4, v4, v232, v233
v_max3_f32 v4, v4, v234, v235
v_max3_f32 v4, v4, v236, v237
v_max3_f32 v4, v4, v238, v239
v_mfma_f32_32x32x16_bf16 v[224:239], v[100:103], v[108:111], v[64:79]
s_nop 11
v_max3_f32 v5, v5, v224, v225
v_max3_f32 v5, v5, v226, v227
v_max3_f32 v5, v5, v228, v229
v_max3_f32 v5, v5, v230, v231
v_max3_f32 v5, v5, v232, v233
v_max3_f32 v5, v5, v234, v235
v_max3_f32 v5, v5, v236, v237
v_max3_f32 v5, v5, v238, v239
v_mfma_f32_32x32x16_bf16 v[224:239], v[96:99], v[108:111], 0
s_nop 11
v_max3_f32 v5, v5, v224, v225
v_max3_f32 v5, v5, v226, v227
v_max3_f32 v5, v5, v228, v229
v_max3_f32 v5, v5, v230, v231
v_max3_f32 v5, v5, v232, v233
v_max3_f32 v5, v5, v234, v235
v_max3_f32 v5, v5, v236, v237
v_max3_f32 v5, v5, v238, v239
s_cmp_lt_u32 s4, 1
s_cbranch_scc1 L_slow_e0
v_mfma_f32_32x32x16_bf16 v[224:239], v[132:135], v[104:107], 0
s_nop 11
v_max3_f32 v4, v4, v224, v225
v_max3_f32 v4, v4, v226, v227
v_max3_f32 v4, v4, v228, v229
v_max3_f32 v4, v4, v230, v231
v_max3_f32 v4, v4, v232, v233
v_max3_f32 v4, v4, v234, v235
v_max3_f32 v4, v4, v236, v237
v_max3_f32 v4, v4, v238, v239
v_mfma_f32_32x32x16_bf16 v[224:239], v[132:135], v[108:111], 0
s_nop 11
v_max3_f32 v5, v5, v224, v225
v_max3_f32 v5, v5, v226, v227
v_max3_f32 v5, v5, v228, v229
v_max3_f32 v5, v5, v230, v231
v_max3_f32 v5, v5, v232, v233
v_max3_f32 v5, v5, v234, v235
v_max3_f32 v5, v5, v236, v237
v_max3_f32 v5, v5, v238, v239
v_mfma_f32_32x32x16_bf16 v[224:239], v[128:131], v[104:107], 0
s_nop 11
v_max3_f32 v4, v4, v224, v225
v_max3_f32 v4, v4, v226, v227
v_max3_f32 v4, v4, v228, v229
v_max3_f32 v4, v4, v230, v231
v_max3_f32 v4, v4, v232, v233
v_max3_f32 v4, v4, v234, v235
v_max3_f32 v4, v4, v236, v237
v_max3_f32 v4, v4, v238, v239
v_mfma_f32_32x32x16_bf16 v[224:239], v[128:131], v[108:111], 0
s_nop 11
v_max3_f32 v5, v5, v224, v225
v_max3_f32 v5, v5, v226, v227
v_max3_f32 v5, v5, v228, v229
v_max3_f32 v5, v5, v230, v231
v_max3_f32 v5, v5, v232, v233
v_max3_f32 v5, v5, v234, v235
v_max3_f32 v5, v5, v236, v237
v_max3_f32 v5, v5, v238, v239
s_cmp_lt_u32 s4, 2
s_cbranch_scc1 L_slow_e0
v_mfma_f32_32x32x16_bf16 v[224:239], v[156:159], v[104:107], 0
s_nop 11
v_max3_f32 v4, v4, v224, v225
v_max3_f32 v4, v4, v226, v227
v_max3_f32 v4, v4, v228, v229
v_max3_f32 v4, v4, v230, v231
v_max3_f32 v4, v4, v232, v233
v_max3_f32 v4, v4, v234, v235
v_max3_f32 v4, v4, v236, v237
v_max3_f32 v4, v4, v238, v239
v_mfma_f32_32x32x16_bf16 v[224:239], v[156:159], v[108:111], 0
s_nop 11
v_max3_f32 v5, v5, v224, v225
v_max3_f32 v5, v5, v226, v227
v_max3_f32 v5, v5, v228, v229
v_max3_f32 v5, v5, v230, v231
v_max3_f32 v5, v5, v232, v233
v_max3_f32 v5, v5, v234, v235
v_max3_f32 v5, v5, v236, v237
v_max3_f32 v5, v5, v238, v239
v_mfma_f32_32x32x16_bf16 v[224:239], v[152:155], v[104:107], 0
s_nop 11
v_max3_f32 v4, v4, v224, v225
v_max3_f32 v4, v4, v226, v227
v_max3_f32 v4, v4, v228, v229
v_max3_f32 v4, v4, v230, v231
v_max3_f32 v4, v4, v232, v233
v_max3_f32 v4, v4, v234, v235
v_max3_f32 v4, v4, v236, v237
v_max3_f32 v4, v4, v238, v239
v_mfma_f32_32x32x16_bf16 v[224:239], v[152:155], v[108:111], 0
s_nop 11
v_max3_f32 v5, v5, v224, v225
v_max3_f32 v5, v5, v226, v227
v_max3_f32 v5, v5, v228, v229
v_max3_f32 v5, v5, v230, v231
v_max3_f32 v5, v5, v232, v233
v_max3_f32 v5, v5, v234, v235
v_max3_f32 v5, v5, v236, v237
v_max3_f32 v5, v5, v238, v239
s_cmp_lt_u32 s4, 3
s_cbranch_scc1 L_slow_e0
v_mfma_f32_32x32x16_bf16 v[224:239], v[180:183], v[104:107], 0
s_nop 11
v_max3_f32 v4, v4, v224, v225
v_max3_f32 v4, v4, v226, v227
v_max3_f32 v4, v4, v228, v229
v_max3_f32 v4, v4, v230, v231
v_max3_f32 v4, v4, v232, v233
v_max3_f32 v4, v4, v234, v235
v_max3_f32 v4, v4, v236, v237
v_max3_f32 v4, v4, v238, v239
v_mfma_f32_32x32x16_bf16 v[224:239], v[180:183], v[108:111], 0
s_nop 11
v_max3_f32 v5, v5, v224, v225
v_max3_f32 v5, v5, v226, v227
v_max3_f32 v5, v5, v228, v229
v_max3_f32 v5, v5, v230, v231
v_max3_f32 v5, v5, v232, v233
v_max3_f32 v5, v5, v234, v235
v_max3_f32 v5, v5, v236, v237
v_max3_f32 v5, v5, v238, v239
v_mfma_f32_32x32x16_bf16 v[224:239], v[176:179], v[104:107], 0
s_nop 11
v_max3_f32 v4, v4, v224, v225
v_max3_f32 v4, v4, v226, v227
v_max3_f32 v4, v4, v228, v229
v_max3_f32 v4, v4, v230, v231
v_max3_f32 v4, v4, v232, v233
v_max3_f32 v4, v4, v234, v235
v_max3_f32 v4, v4, v236, v237
v_max3_f32 v4, v4, v238, v239
v_mfma_f32_32x32x16_bf16 v[224:239], v[176:179], v[108:111], 0
s_nop 11
v_max3_f32 v5, v5, v224, v225
v_max3_f32 v5, v5, v226, v227
v_max3_f32 v5, v5, v228, v229
v_max3_f32 v5, v5, v230, v231
v_max3_f32 v5, v5, v232, v233
v_max3_f32 v5, v5, v234, v235
v_max3_f32 v5, v5, v236, v237
v_max3_f32 v5, v5, v238, v239
s_cmp_lt_u32 s4, 4
s_cbranch_scc1 L_slow_e0
v_mfma_f32_32x32x16_bf16 v[224:239], v[204:207], v[104:107], 0
s_nop 11
v_max3_f32 v4, v4, v224, v225
v_max3_f32 v4, v4, v226, v227
v_max3_f32 v4, v4, v228, v229
v_max3_f32 v4, v4, v230, v231
v_max3_f32 v4, v4, v232, v233
v_max3_f32 v4, v4, v234, v235
v_max3_f32 v4, v4, v236, v237
v_max3_f32 v4, v4, v238, v239
v_mfma_f32_32x32x16_bf16 v[224:239], v[204:207], v[108:111], v[80:95]
s_nop 11
v_max3_f32 v5, v5, v224, v225
v_max3_f32 v5, v5, v226, v227
v_max3_f32 v5, v5, v228, v229
v_max3_f32 v5, v5, v230, v231
v_max3_f32 v5, v5, v232, v233
v_max3_f32 v5, v5, v234, v235
v_max3_f32 v5, v5, v236, v237
v_max3_f32 v5, v5, v238, v239
v_mfma_f32_32x32x16_bf16 v[224:239], v[200:203], v[104:107], v[80:95]
s_nop 11
v_max3_f32 v4, v4, v224, v225
v_max3_f32 v4, v4, v226, v227
v_max3_f32 v4, v4, v228, v229
v_max3_f32 v4, v4, v230, v231
v_max3_f32 v4, v4, v232, v233
v_max3_f32 v4, v4, v234, v235
v_max3_f32 v4, v4, v236, v237
v_max3_f32 v4, v4, v238, v239
L_slow_e0:
s_nop 15
v_mov_b32 v6, v4
v_mov_b32 v7, v5
s_nop 1
v_permlane32_swap_b32 v4, v6
v_permlane32_swap_b32 v5, v7
s_nop 1
v_max_f32 v4, v4, v6
v_max_f32 v5, v5, v7
v_mfma_f32_32x32x16_bf16 v[224:239], v[96:99], v[104:107], v[64:79]
s_nop 11
v_sub_f32 v224, v224, v4
v_exp_f32 v224, v224
v_sub_f32 v225, v225, v4
v_exp_f32 v225, v225
v_sub_f32 v226, v226, v4
v_exp_f32 v226, v226
v_sub_f32 v227, v227, v4
v_exp_f32 v227, v227
v_sub_f32 v228, v228, v4
v_exp_f32 v228, v228
v_sub_f32 v229, v229, v4
v_exp_f32 v229, v229
v_sub_f32 v230, v230, v4
v_exp_f32 v230, v230
v_sub_f32 v231, v231, v4
v_exp_f32 v231, v231
v_sub_f32 v232, v232, v4
v_exp_f32 v232, v232
v_sub_f32 v233, v233, v4
v_exp_f32 v233, v233
v_sub_f32 v234, v234, v4
v_exp_f32 v234, v234
v_sub_f32 v235, v235, v4
v_exp_f32 v235, v235
v_sub_f32 v236, v236, v4
v_exp_f32 v236, v236
v_sub_f32 v237, v237, v4
v_exp_f32 v237, v237
v_sub_f32 v238, v238, v4
v_exp_f32 v238, v238
v_sub_f32 v239, v239, v4
v_exp_f32 v239, v239
v_cvt_pk_bf16_f32 v24, v224, v225
v_cvt_pk_bf16_f32 v25, v226, v227
v_cvt_pk_bf16_f32 v26, v228, v229
v_cvt_pk_bf16_f32 v27, v230, v231
v_cvt_pk_bf16_f32 v28, v232, v233
v_cvt_pk_bf16_f32 v29, v234, v235
v_cvt_pk_bf16_f32 v30, v236, v237
v_cvt_pk_bf16_f32 v31, v238, v239
v_mfma_f32_32x32x16_bf16 v[32:47], v[112:115], v[24:27], 0
s_nop 0
v_mfma_f32_32x32x16_bf16 v[32:47], v[116:119], v[28:31], v[32:47]
v_mfma_f32_32x32x16_bf16 v[224:239], v[100:103], v[108:111], v[64:79]
s_nop 11
v_sub_f32 v224, v224, v5
v_exp_f32 v224, v224
v_sub_f32 v225, v225, v5
v_exp_f32 v225, v225
v_sub_f32 v226, v226, v5
v_exp_f32 v226, v226
v_sub_f32 v227, v227, v5
v_exp_f32 v227, v227
v_sub_f32 v228, v228, v5
v_exp_f32 v228, v228
v_sub_f32 v229, v229, v5
v_exp_f32 v229, v229
v_sub_f32 v230, v230, v5
v_exp_f32 v230, v230
v_sub_f32 v231, v231, v5
v_exp_f32 v231, v231
v_sub_f32 v232, v232, v5
v_exp_f32 v232, v232
v_sub_f32 v233, v233, v5
v_exp_f32 v233, v233
v_sub_f32 v234, v234, v5
v_exp_f32 v234, v234
v_sub_f32 v235, v235, v5
v_exp_f32 v235, v235
v_sub_f32 v236, v236, v5
v_exp_f32 v236, v236
v_sub_f32 v237, v237, v5
v_exp_f32 v237, v237
v_sub_f32 v238, v238, v5
v_exp_f32 v238, v238
v_sub_f32 v239, v239, v5
v_exp_f32 v239, v239
v_cvt_pk_bf16_f32 v24, v224, v225
v_cvt_pk_bf16_f32 v25, v226, v227
v_cvt_pk_bf16_f32 v26, v228, v229
v_cvt_pk_bf16_f32 v27, v230, v231
v_cvt_pk_bf16_f32 v28, v232, v233
v_cvt_pk_bf16_f32 v29, v234, v235
v_cvt_pk_bf16_f32 v30, v236, v237
v_cvt_pk_bf16_f32 v31, v238, v239
v_mfma_f32_32x32x16_bf16 v[48:63], v[120:123], v[24:27], 0
s_nop 0
v_mfma_f32_32x32x16_bf16 v[48:63], v[124:127], v[28:31], v[48:63]
v_mfma_f32_32x32x16_bf16 v[224:239], v[96:99], v[108:111], 0
s_nop 11
v_sub_f32 v224, v224, v5
v_exp_f32 v224, v224
v_sub_f32 v225, v225, v5
v_exp_f32 v225, v225
v_sub_f32 v226, v226, v5
v_exp_f32 v226, v226
v_sub_f32 v227, v227, v5
v_exp_f32 v227, v227
v_sub_f32 v228, v228, v5
v_exp_f32 v228, v228
v_sub_f32 v229, v229, v5
v_exp_f32 v229, v229
v_sub_f32 v230, v230, v5
v_exp_f32 v230, v230
v_sub_f32 v231, v231, v5
v_exp_f32 v231, v231
v_sub_f32 v232, v232, v5
v_exp_f32 v232, v232
v_sub_f32 v233, v233, v5
v_exp_f32 v233, v233
v_sub_f32 v234, v234, v5
v_exp_f32 v234, v234
v_sub_f32 v235, v235, v5
v_exp_f32 v235, v235
v_sub_f32 v236, v236, v5
v_exp_f32 v236, v236
v_sub_f32 v237, v237, v5
v_exp_f32 v237, v237
v_sub_f32 v238, v238, v5
v_exp_f32 v238, v238
v_sub_f32 v239, v239, v5
v_exp_f32 v239, v239
v_cvt_pk_bf16_f32 v24, v224, v225
v_cvt_pk_bf16_f32 v25, v226, v227
v_cvt_pk_bf16_f32 v26, v228, v229
v_cvt_pk_bf16_f32 v27, v230, v231
v_cvt_pk_bf16_f32 v28, v232, v233
v_cvt_pk_bf16_f32 v29, v234, v235
v_cvt_pk_bf16_f32 v30, v236, v237
v_cvt_pk_bf16_f32 v31, v238, v239
v_mfma_f32_32x32x16_bf16 v[48:63], v[112:115], v[24:27], v[48:63]
s_nop 0
v_mfma_f32_32x32x16_bf16 v[48:63], v[116:119], v[28:31], v[48:63]
s_cmp_lt_u32 s4, 1
s_cbranch_scc1 L_slow_e1
v_mfma_f32_32x32x16_bf16 v[224:239], v[132:135], v[104:107], 0
s_nop 11
v_sub_f32 v224, v224, v4
v_exp_f32 v224, v224
v_sub_f32 v225, v225, v4
v_exp_f32 v225, v225
v_sub_f32 v226, v226, v4
v_exp_f32 v226, v226
v_sub_f32 v227, v227, v4
v_exp_f32 v227, v227
v_sub_f32 v228, v228, v4
v_exp_f32 v228, v228
v_sub_f32 v229, v229, v4
v_exp_f32 v229, v229
v_sub_f32 v230, v230, v4
v_exp_f32 v230, v230
v_sub_f32 v231, v231, v4
v_exp_f32 v231, v231
v_sub_f32 v232, v232, v4
v_exp_f32 v232, v232
v_sub_f32 v233, v233, v4
v_exp_f32 v233, v233
v_sub_f32 v234, v234, v4
v_exp_f32 v234, v234
v_sub_f32 v235, v235, v4
v_exp_f32 v235, v235
v_sub_f32 v236, v236, v4
v_exp_f32 v236, v236
v_sub_f32 v237, v237, v4
v_exp_f32 v237, v237
v_sub_f32 v238, v238, v4
v_exp_f32 v238, v238
v_sub_f32 v239, v239, v4
v_exp_f32 v239, v239
v_cvt_pk_bf16_f32 v24, v224, v225
v_cvt_pk_bf16_f32 v25, v226, v227
v_cvt_pk_bf16_f32 v26, v228, v229
v_cvt_pk_bf16_f32 v27, v230, v231
v_cvt_pk_bf16_f32 v28, v232, v233
v_cvt_pk_bf16_f32 v29, v234, v235
v_cvt_pk_bf16_f32 v30, v236, v237
v_cvt_pk_bf16_f32 v31, v238, v239
v_mfma_f32_32x32x16_bf16 v[32:47], v[144:147], v[24:27], v[32:47]
s_nop 0
v_mfma_f32_32x32x16_bf16 v[32:47], v[148:151], v[28:31], v[32:47]
v_mfma_f32_32x32x16_bf16 v[224:239], v[132:135], v[108:111], 0
s_nop 11
v_sub_f32 v224, v224, v5
v_exp_f32 v224, v224
v_sub_f32 v225, v225, v5
v_exp_f32 v225, v225
v_sub_f32 v226, v226, v5
v_exp_f32 v226, v226
v_sub_f32 v227, v227, v5
v_exp_f32 v227, v227
v_sub_f32 v228, v228, v5
v_exp_f32 v228, v228
v_sub_f32 v229, v229, v5
v_exp_f32 v229, v229
v_sub_f32 v230, v230, v5
v_exp_f32 v230, v230
v_sub_f32 v231, v231, v5
v_exp_f32 v231, v231
v_sub_f32 v232, v232, v5
v_exp_f32 v232, v232
v_sub_f32 v233, v233, v5
v_exp_f32 v233, v233
v_sub_f32 v234, v234, v5
v_exp_f32 v234, v234
v_sub_f32 v235, v235, v5
v_exp_f32 v235, v235
v_sub_f32 v236, v236, v5
v_exp_f32 v236, v236
v_sub_f32 v237, v237, v5
v_exp_f32 v237, v237
v_sub_f32 v238, v238, v5
v_exp_f32 v238, v238
v_sub_f32 v239, v239, v5
v_exp_f32 v239, v239
v_cvt_pk_bf16_f32 v24, v224, v225
v_cvt_pk_bf16_f32 v25, v226, v227
v_cvt_pk_bf16_f32 v26, v228, v229
v_cvt_pk_bf16_f32 v27, v230, v231
v_cvt_pk_bf16_f32 v28, v232, v233
v_cvt_pk_bf16_f32 v29, v234, v235
v_cvt_pk_bf16_f32 v30, v236, v237
v_cvt_pk_bf16_f32 v31, v238, v239
v_mfma_f32_32x32x16_bf16 v[48:63], v[144:147], v[24:27], v[48:63]
s_nop 0
v_mfma_f32_32x32x16_bf16 v[48:63], v[148:151], v[28:31], v[48:63]
v_mfma_f32_32x32x16_bf16 v[224:239], v[128:131], v[104:107], 0
s_nop 11
v_sub_f32 v224, v224, v4
v_exp_f32 v224, v224
v_sub_f32 v225, v225, v4
v_exp_f32 v225, v225
v_sub_f32 v226, v226, v4
v_exp_f32 v226, v226
v_sub_f32 v227, v227, v4
v_exp_f32 v227, v227
v_sub_f32 v228, v228, v4
v_exp_f32 v228, v228
v_sub_f32 v229, v229, v4
v_exp_f32 v229, v229
v_sub_f32 v230, v230, v4
v_exp_f32 v230, v230
v_sub_f32 v231, v231, v4
v_exp_f32 v231, v231
v_sub_f32 v232, v232, v4
v_exp_f32 v232, v232
v_sub_f32 v233, v233, v4
v_exp_f32 v233, v233
v_sub_f32 v234, v234, v4
v_exp_f32 v234, v234
v_sub_f32 v235, v235, v4
v_exp_f32 v235, v235
v_sub_f32 v236, v236, v4
v_exp_f32 v236, v236
v_sub_f32 v237, v237, v4
v_exp_f32 v237, v237
v_sub_f32 v238, v238, v4
v_exp_f32 v238, v238
v_sub_f32 v239, v239, v4
v_exp_f32 v239, v239
v_cvt_pk_bf16_f32 v24, v224, v225
v_cvt_pk_bf16_f32 v25, v226, v227
v_cvt_pk_bf16_f32 v26, v228, v229
v_cvt_pk_bf16_f32 v27, v230, v231
v_cvt_pk_bf16_f32 v28, v232, v233
v_cvt_pk_bf16_f32 v29, v234, v235
v_cvt_pk_bf16_f32 v30, v236, v237
v_cvt_pk_bf16_f32 v31, v238, v239
v_mfma_f32_32x32x16_bf16 v[32:47], v[136:139], v[24:27], v[32:47]
s_nop 0
v_mfma_f32_32x32x16_bf16 v[32:47], v[140:143], v[28:31], v[32:47]
v_mfma_f32_32x32x16_bf16 v[224:239], v[128:131], v[108:111], 0
s_nop 11
v_sub_f32 v224, v224, v5
v_exp_f32 v224, v224
v_sub_f32 v225, v225, v5
v_exp_f32 v225, v225
v_sub_f32 v226, v226, v5
v_exp_f32 v226, v226
v_sub_f32 v227, v227, v5
v_exp_f32 v227, v227
v_sub_f32 v228, v228, v5
v_exp_f32 v228, v228
v_sub_f32 v229, v229, v5
v_exp_f32 v229, v229
v_sub_f32 v230, v230, v5
v_exp_f32 v230, v230
v_sub_f32 v231, v231, v5
v_exp_f32 v231, v231
v_sub_f32 v232, v232, v5
v_exp_f32 v232, v232
v_sub_f32 v233, v233, v5
v_exp_f32 v233, v233
v_sub_f32 v234, v234, v5
v_exp_f32 v234, v234
v_sub_f32 v235, v235, v5
v_exp_f32 v235, v235
v_sub_f32 v236, v236, v5
v_exp_f32 v236, v236
v_sub_f32 v237, v237, v5
v_exp_f32 v237, v237
v_sub_f32 v238, v238, v5
v_exp_f32 v238, v238
v_sub_f32 v239, v239, v5
v_exp_f32 v239, v239
v_cvt_pk_bf16_f32 v24, v224, v225
v_cvt_pk_bf16_f32 v25, v226, v227
v_cvt_pk_bf16_f32 v26, v228, v229
v_cvt_pk_bf16_f32 v27, v230, v231
v_cvt_pk_bf16_f32 v28, v232, v233
v_cvt_pk_bf16_f32 v29, v234, v235
v_cvt_pk_bf16_f32 v30, v236, v237
v_cvt_pk_bf16_f32 v31, v238, v239
v_mfma_f32_32x32x16_bf16 v[48:63], v[136:139], v[24:27], v[48:63]
s_nop 0
v_mfma_f32_32x32x16_bf16 v[48:63], v[140:143], v[28:31], v[48:63]
s_cmp_lt_u32 s4, 2
s_cbranch_scc1 L_slow_e1
v_mfma_f32_32x32x16_bf16 v[224:239], v[156:159], v[104:107], 0
s_nop 11
v_sub_f32 v224, v224, v4
v_exp_f32 v224, v224
v_sub_f32 v225, v225, v4
v_exp_f32 v225, v225
v_sub_f32 v226, v226, v4
v_exp_f32 v226, v226
v_sub_f32 v227, v227, v4
v_exp_f32 v227, v227
v_sub_f32 v228, v228, v4
v_exp_f32 v228, v228
v_sub_f32 v229, v229, v4
v_exp_f32 v229, v229
v_sub_f32 v230, v230, v4
v_exp_f32 v230, v230
v_sub_f32 v231, v231, v4
v_exp_f32 v231, v231
v_sub_f32 v232, v232, v4
v_exp_f32 v232, v232
v_sub_f32 v233, v233, v4
v_exp_f32 v233, v233
v_sub_f32 v234, v234, v4
v_exp_f32 v234, v234
v_sub_f32 v235, v235, v4
v_exp_f32 v235, v235
v_sub_f32 v236, v236, v4
v_exp_f32 v236, v236
v_sub_f32 v237, v237, v4
v_exp_f32 v237, v237
v_sub_f32 v238, v238, v4
v_exp_f32 v238, v238
v_sub_f32 v239, v239, v4
v_exp_f32 v239, v239
v_cvt_pk_bf16_f32 v24, v224, v225
v_cvt_pk_bf16_f32 v25, v226, v227
v_cvt_pk_bf16_f32 v26, v228, v229
v_cvt_pk_bf16_f32 v27, v230, v231
v_cvt_pk_bf16_f32 v28, v232, v233
v_cvt_pk_bf16_f32 v29, v234, v235
v_cvt_pk_bf16_f32 v30, v236, v237
v_cvt_pk_bf16_f32 v31, v238, v239
v_mfma_f32_32x32x16_bf16 v[32:47], v[168:171], v[24:27], v[32:47]
s_nop 0
v_mfma_f32_32x32x16_bf16 v[32:47], v[172:175], v[28:31], v[32:47]
v_mfma_f32_32x32x16_bf16 v[224:239], v[156:159], v[108:111], 0
s_nop 11
v_sub_f32 v224, v224, v5
v_exp_f32 v224, v224
v_sub_f32 v225, v225, v5
v_exp_f32 v225, v225
v_sub_f32 v226, v226, v5
v_exp_f32 v226, v226
v_sub_f32 v227, v227, v5
v_exp_f32 v227, v227
v_sub_f32 v228, v228, v5
v_exp_f32 v228, v228
v_sub_f32 v229, v229, v5
v_exp_f32 v229, v229
v_sub_f32 v230, v230, v5
v_exp_f32 v230, v230
v_sub_f32 v231, v231, v5
v_exp_f32 v231, v231
v_sub_f32 v232, v232, v5
v_exp_f32 v232, v232
v_sub_f32 v233, v233, v5
v_exp_f32 v233, v233
v_sub_f32 v234, v234, v5
v_exp_f32 v234, v234
v_sub_f32 v235, v235, v5
v_exp_f32 v235, v235
v_sub_f32 v236, v236, v5
v_exp_f32 v236, v236
v_sub_f32 v237, v237, v5
v_exp_f32 v237, v237
v_sub_f32 v238, v238, v5
v_exp_f32 v238, v238
v_sub_f32 v239, v239, v5
v_exp_f32 v239, v239
v_cvt_pk_bf16_f32 v24, v224, v225
v_cvt_pk_bf16_f32 v25, v226, v227
v_cvt_pk_bf16_f32 v26, v228, v229
v_cvt_pk_bf16_f32 v27, v230, v231
v_cvt_pk_bf16_f32 v28, v232, v233
v_cvt_pk_bf16_f32 v29, v234, v235
v_cvt_pk_bf16_f32 v30, v236, v237
v_cvt_pk_bf16_f32 v31, v238, v239
v_mfma_f32_32x32x16_bf16 v[48:63], v[168:171], v[24:27], v[48:63]
s_nop 0
v_mfma_f32_32x32x16_bf16 v[48:63], v[172:175], v[28:31], v[48:63]
v_mfma_f32_32x32x16_bf16 v[224:239], v[152:155], v[104:107], 0
s_nop 11
v_sub_f32 v224, v224, v4
v_exp_f32 v224, v224
v_sub_f32 v225, v225, v4
v_exp_f32 v225, v225
v_sub_f32 v226, v226, v4
v_exp_f32 v226, v226
v_sub_f32 v227, v227, v4
v_exp_f32 v227, v227
v_sub_f32 v228, v228, v4
v_exp_f32 v228, v228
v_sub_f32 v229, v229, v4
v_exp_f32 v229, v229
v_sub_f32 v230, v230, v4
v_exp_f32 v230, v230
v_sub_f32 v231, v231, v4
v_exp_f32 v231, v231
v_sub_f32 v232, v232, v4
v_exp_f32 v232, v232
v_sub_f32 v233, v233, v4
v_exp_f32 v233, v233
v_sub_f32 v234, v234, v4
v_exp_f32 v234, v234
v_sub_f32 v235, v235, v4
v_exp_f32 v235, v235
v_sub_f32 v236, v236, v4
v_exp_f32 v236, v236
v_sub_f32 v237, v237, v4
v_exp_f32 v237, v237
v_sub_f32 v238, v238, v4
v_exp_f32 v238, v238
v_sub_f32 v239, v239, v4
v_exp_f32 v239, v239
v_cvt_pk_bf16_f32 v24, v224, v225
v_cvt_pk_bf16_f32 v25, v226, v227
v_cvt_pk_bf16_f32 v26, v228, v229
v_cvt_pk_bf16_f32 v27, v230, v231
v_cvt_pk_bf16_f32 v28, v232, v233
v_cvt_pk_bf16_f32 v29, v234, v235
v_cvt_pk_bf16_f32 v30, v236, v237
v_cvt_pk_bf16_f32 v31, v238, v239
v_mfma_f32_32x32x16_bf16 v[32:47], v[160:163], v[24:27], v[32:47]
s_nop 0
v_mfma_f32_32x32x16_bf16 v[32:47], v[164:167], v[28:31], v[32:47]
v_mfma_f32_32x32x16_bf16 v[224:239], v[152:155], v[108:111], 0
s_nop 11
v_sub_f32 v224, v224, v5
v_exp_f32 v224, v224
v_sub_f32 v225, v225, v5
v_exp_f32 v225, v225
v_sub_f32 v226, v226, v5
v_exp_f32 v226, v226
v_sub_f32 v227, v227, v5
v_exp_f32 v227, v227
v_sub_f32 v228, v228, v5
v_exp_f32 v228, v228
v_sub_f32 v229, v229, v5
v_exp_f32 v229, v229
v_sub_f32 v230, v230, v5
v_exp_f32 v230, v230
v_sub_f32 v231, v231, v5
v_exp_f32 v231, v231
v_sub_f32 v232, v232, v5
v_exp_f32 v232, v232
v_sub_f32 v233, v233, v5
v_exp_f32 v233, v233
v_sub_f32 v234, v234, v5
v_exp_f32 v234, v234
v_sub_f32 v235, v235, v5
v_exp_f32 v235, v235
v_sub_f32 v236, v236, v5
v_exp_f32 v236, v236
v_sub_f32 v237, v237, v5
v_exp_f32 v237, v237
v_sub_f32 v238, v238, v5
v_exp_f32 v238, v238
v_sub_f32 v239, v239, v5
v_exp_f32 v239, v239
v_cvt_pk_bf16_f32 v24, v224, v225
v_cvt_pk_bf16_f32 v25, v226, v227
v_cvt_pk_bf16_f32 v26, v228, v229
v_cvt_pk_bf16_f32 v27, v230, v231
v_cvt_pk_bf16_f32 v28, v232, v233
v_cvt_pk_bf16_f32 v29, v234, v235
v_cvt_pk_bf16_f32 v30, v236, v237
v_cvt_pk_bf16_f32 v31, v238, v239
v_mfma_f32_32x32x16_bf16 v[48:63], v[160:163], v[24:27], v[48:63]
s_nop 0
v_mfma_f32_32x32x16_bf16 v[48:63], v[164:167], v[28:31], v[48:63]
s_cmp_lt_u32 s4, 3
s_cbranch_scc1 L_slow_e1
v_mfma_f32_32x32x16_bf16 v[224:239], v[180:183], v[104:107], 0
s_nop 11
v_sub_f32 v224, v224, v4
v_exp_f32 v224, v224
v_sub_f32 v225, v225, v4
v_exp_f32 v225, v225
v_sub_f32 v226, v226, v4
v_exp_f32 v226, v226
v_sub_f32 v227, v227, v4
v_exp_f32 v227, v227
v_sub_f32 v228, v228, v4
v_exp_f32 v228, v228
v_sub_f32 v229, v229, v4
v_exp_f32 v229, v229
v_sub_f32 v230, v230, v4
v_exp_f32 v230, v230
v_sub_f32 v231, v231, v4
v_exp_f32 v231, v231
v_sub_f32 v232, v232, v4
v_exp_f32 v232, v232
v_sub_f32 v233, v233, v4
v_exp_f32 v233, v233
v_sub_f32 v234, v234, v4
v_exp_f32 v234, v234
v_sub_f32 v235, v235, v4
v_exp_f32 v235, v235
v_sub_f32 v236, v236, v4
v_exp_f32 v236, v236
v_sub_f32 v237, v237, v4
v_exp_f32 v237, v237
v_sub_f32 v238, v238, v4
v_exp_f32 v238, v238
v_sub_f32 v239, v239, v4
v_exp_f32 v239, v239
v_cvt_pk_bf16_f32 v24, v224, v225
v_cvt_pk_bf16_f32 v25, v226, v227
v_cvt_pk_bf16_f32 v26, v228, v229
v_cvt_pk_bf16_f32 v27, v230, v231
v_cvt_pk_bf16_f32 v28, v232, v233
v_cvt_pk_bf16_f32 v29, v234, v235
v_cvt_pk_bf16_f32 v30, v236, v237
v_cvt_pk_bf16_f32 v31, v238, v239
v_mfma_f32_32x32x16_bf16 v[32:47], v[192:195], v[24:27], v[32:47]
s_nop 0
v_mfma_f32_32x32x16_bf16 v[32:47], v[196:199], v[28:31], v[32:47]
v_mfma_f32_32x32x16_bf16 v[224:239], v[180:183], v[108:111], 0
s_nop 11
v_sub_f32 v224, v224, v5
v_exp_f32 v224, v224
v_sub_f32 v225, v225, v5
v_exp_f32 v225, v225
v_sub_f32 v226, v226, v5
v_exp_f32 v226, v226
v_sub_f32 v227, v227, v5
v_exp_f32 v227, v227
v_sub_f32 v228, v228, v5
v_exp_f32 v228, v228
v_sub_f32 v229, v229, v5
v_exp_f32 v229, v229
v_sub_f32 v230, v230, v5
v_exp_f32 v230, v230
v_sub_f32 v231, v231, v5
v_exp_f32 v231, v231
v_sub_f32 v232, v232, v5
v_exp_f32 v232, v232
v_sub_f32 v233, v233, v5
v_exp_f32 v233, v233
v_sub_f32 v234, v234, v5
v_exp_f32 v234, v234
v_sub_f32 v235, v235, v5
v_exp_f32 v235, v235
v_sub_f32 v236, v236, v5
v_exp_f32 v236, v236
v_sub_f32 v237, v237, v5
v_exp_f32 v237, v237
v_sub_f32 v238, v238, v5
v_exp_f32 v238, v238
v_sub_f32 v239, v239, v5
v_exp_f32 v239, v239
v_cvt_pk_bf16_f32 v24, v224, v225
v_cvt_pk_bf16_f32 v25, v226, v227
v_cvt_pk_bf16_f32 v26, v228, v229
v_cvt_pk_bf16_f32 v27, v230, v231
v_cvt_pk_bf16_f32 v28, v232, v233
v_cvt_pk_bf16_f32 v29, v234, v235
v_cvt_pk_bf16_f32 v30, v236, v237
v_cvt_pk_bf16_f32 v31, v238, v239
v_mfma_f32_32x32x16_bf16 v[48:63], v[192:195], v[24:27], v[48:63]
s_nop 0
v_mfma_f32_32x32x16_bf16 v[48:63], v[196:199], v[28:31], v[48:63]
v_mfma_f32_32x32x16_bf16 v[224:239], v[176:179], v[104:107], 0
s_nop 11
v_sub_f32 v224, v224, v4
v_exp_f32 v224, v224
v_sub_f32 v225, v225, v4
v_exp_f32 v225, v225
v_sub_f32 v226, v226, v4
v_exp_f32 v226, v226
v_sub_f32 v227, v227, v4
v_exp_f32 v227, v227
v_sub_f32 v228, v228, v4
v_exp_f32 v228, v228
v_sub_f32 v229, v229, v4
v_exp_f32 v229, v229
v_sub_f32 v230, v230, v4
v_exp_f32 v230, v230
v_sub_f32 v231, v231, v4
v_exp_f32 v231, v231
v_sub_f32 v232, v232, v4
v_exp_f32 v232, v232
v_sub_f32 v233, v233, v4
v_exp_f32 v233, v233
v_sub_f32 v234, v234, v4
v_exp_f32 v234, v234
v_sub_f32 v235, v235, v4
v_exp_f32 v235, v235
v_sub_f32 v236, v236, v4
v_exp_f32 v236, v236
v_sub_f32 v237, v237, v4
v_exp_f32 v237, v237
v_sub_f32 v238, v238, v4
v_exp_f32 v238, v238
v_sub_f32 v239, v239, v4
v_exp_f32 v239, v239
v_cvt_pk_bf16_f32 v24, v224, v225
v_cvt_pk_bf16_f32 v25, v226, v227
v_cvt_pk_bf16_f32 v26, v228, v229
v_cvt_pk_bf16_f32 v27, v230, v231
v_cvt_pk_bf16_f32 v28, v232, v233
v_cvt_pk_bf16_f32 v29, v234, v235
v_cvt_pk_bf16_f32 v30, v236, v237
v_cvt_pk_bf16_f32 v31, v238, v239
v_mfma_f32_32x32x16_bf16 v[32:47], v[184:187], v[24:27], v[32:47]
s_nop 0
v_mfma_f32_32x32x16_bf16 v[32:47], v[188:191], v[28:31], v[32:47]
v_mfma_f32_32x32x16_bf16 v[224:239], v[176:179], v[108:111], 0
s_nop 11
v_sub_f32 v224, v224, v5
v_exp_f32 v224, v224
v_sub_f32 v225, v225, v5
v_exp_f32 v225, v225
v_sub_f32 v226, v226, v5
v_exp_f32 v226, v226
v_sub_f32 v227, v227, v5
v_exp_f32 v227, v227
v_sub_f32 v228, v228, v5
v_exp_f32 v228, v228
v_sub_f32 v229, v229, v5
v_exp_f32 v229, v229
v_sub_f32 v230, v230, v5
v_exp_f32 v230, v230
v_sub_f32 v231, v231, v5
v_exp_f32 v231, v231
v_sub_f32 v232, v232, v5
v_exp_f32 v232, v232
v_sub_f32 v233, v233, v5
v_exp_f32 v233, v233
v_sub_f32 v234, v234, v5
v_exp_f32 v234, v234
v_sub_f32 v235, v235, v5
v_exp_f32 v235, v235
v_sub_f32 v236, v236, v5
v_exp_f32 v236, v236
v_sub_f32 v237, v237, v5
v_exp_f32 v237, v237
v_sub_f32 v238, v238, v5
v_exp_f32 v238, v238
v_sub_f32 v239, v239, v5
v_exp_f32 v239, v239
v_cvt_pk_bf16_f32 v24, v224, v225
v_cvt_pk_bf16_f32 v25, v226, v227
v_cvt_pk_bf16_f32 v26, v228, v229
v_cvt_pk_bf16_f32 v27, v230, v231
v_cvt_pk_bf16_f32 v28, v232, v233
v_cvt_pk_bf16_f32 v29, v234, v235
v_cvt_pk_bf16_f32 v30, v236, v237
v_cvt_pk_bf16_f32 v31, v238, v239
v_mfma_f32_32x32x16_bf16 v[48:63], v[184:187], v[24:27], v[48:63]
s_nop 0
v_mfma_f32_32x32x16_bf16 v[48:63], v[188:191], v[28:31], v[48:63]
s_cmp_lt_u32 s4, 4
s_cbranch_scc1 L_slow_e1
v_mfma_f32_32x32x16_bf16 v[224:239], v[204:207], v[104:107], 0
s_nop 11
v_sub_f32 v224, v224, v4
v_exp_f32 v224, v224
v_sub_f32 v225, v225, v4
v_exp_f32 v225, v225
v_sub_f32 v226, v226, v4
v_exp_f32 v226, v226
v_sub_f32 v227, v227, v4
v_exp_f32 v227, v227
v_sub_f32 v228, v228, v4
v_exp_f32 v228, v228
v_sub_f32 v229, v229, v4
v_exp_f32 v229, v229
v_sub_f32 v230, v230, v4
v_exp_f32 v230, v230
v_sub_f32 v231, v231, v4
v_exp_f32 v231, v231
v_sub_f32 v232, v232, v4
v_exp_f32 v232, v232
v_sub_f32 v233, v233, v4
v_exp_f32 v233, v233
v_sub_f32 v234, v234, v4
v_exp_f32 v234, v234
v_sub_f32 v235, v235, v4
v_exp_f32 v235, v235
v_sub_f32 v236, v236, v4
v_exp_f32 v236, v236
v_sub_f32 v237, v237, v4
v_exp_f32 v237, v237
v_sub_f32 v238, v238, v4
v_exp_f32 v238, v238
v_sub_f32 v239, v239, v4
v_exp_f32 v239, v239
v_cvt_pk_bf16_f32 v24, v224, v225
v_cvt_pk_bf16_f32 v25, v226, v227
v_cvt_pk_bf16_f32 v26, v228, v229
v_cvt_pk_bf16_f32 v27, v230, v231
v_cvt_pk_bf16_f32 v28, v232, v233
v_cvt_pk_bf16_f32 v29, v234, v235
v_cvt_pk_bf16_f32 v30, v236, v237
v_cvt_pk_bf16_f32 v31, v238, v239
v_mfma_f32_32x32x16_bf16 v[32:47], v[216:219], v[24:27], v[32:47]
s_nop 0
v_mfma_f32_32x32x16_bf16 v[32:47], v[220:223], v[28:31], v[32:47]
v_mfma_f32_32x32x16_bf16 v[224:239], v[204:207], v[108:111], v[80:95]
s_nop 11
v_sub_f32 v224, v224, v5
v_exp_f32 v224, v224
v_sub_f32 v225, v225, v5
v_exp_f32 v225, v225
v_sub_f32 v226, v226, v5
v_exp_f32 v226, v226
v_sub_f32 v227, v227, v5
v_exp_f32 v227, v227
v_sub_f32 v228, v228, v5
v_exp_f32 v228, v228
v_sub_f32 v229, v229, v5
v_exp_f32 v229, v229
v_sub_f32 v230, v230, v5
v_exp_f32 v230, v230
v_sub_f32 v231, v231, v5
v_exp_f32 v231, v231
v_sub_f32 v232, v232, v5
v_exp_f32 v232, v232
v_sub_f32 v233, v233, v5
v_exp_f32 v233, v233
v_sub_f32 v234, v234, v5
v_exp_f32 v234, v234
v_sub_f32 v235, v235, v5
v_exp_f32 v235, v235
v_sub_f32 v236, v236, v5
v_exp_f32 v236, v236
v_sub_f32 v237, v237, v5
v_exp_f32 v237, v237
v_sub_f32 v238, v238, v5
v_exp_f32 v238, v238
v_sub_f32 v239, v239, v5
v_exp_f32 v239, v239
v_cvt_pk_bf16_f32 v24, v224, v225
v_cvt_pk_bf16_f32 v25, v226, v227
v_cvt_pk_bf16_f32 v26, v228, v229
v_cvt_pk_bf16_f32 v27, v230, v231
v_cvt_pk_bf16_f32 v28, v232, v233
v_cvt_pk_bf16_f32 v29, v234, v235
v_cvt_pk_bf16_f32 v30, v236, v237
v_cvt_pk_bf16_f32 v31, v238, v239
v_mfma_f32_32x32x16_bf16 v[48:63], v[216:219], v[24:27], v[48:63]
s_nop 0
v_mfma_f32_32x32x16_bf16 v[48:63], v[220:223], v[28:31], v[48:63]
v_mfma_f32_32x32x16_bf16 v[224:239], v[200:203], v[104:107], v[80:95]
s_nop 11
v_sub_f32 v224, v224, v4
v_exp_f32 v224, v224
v_sub_f32 v225, v225, v4
v_exp_f32 v225, v225
v_sub_f32 v226, v226, v4
v_exp_f32 v226, v226
v_sub_f32 v227, v227, v4
v_exp_f32 v227, v227
v_sub_f32 v228, v228, v4
v_exp_f32 v228, v228
v_sub_f32 v229, v229, v4
v_exp_f32 v229, v229
v_sub_f32 v230, v230, v4
v_exp_f32 v230, v230
v_sub_f32 v231, v231, v4
v_exp_f32 v231, v231
v_sub_f32 v232, v232, v4
v_exp_f32 v232, v232
v_sub_f32 v233, v233, v4
v_exp_f32 v233, v233
v_sub_f32 v234, v234, v4
v_exp_f32 v234, v234
v_sub_f32 v235, v235, v4
v_exp_f32 v235, v235
v_sub_f32 v236, v236, v4
v_exp_f32 v236, v236
v_sub_f32 v237, v237, v4
v_exp_f32 v237, v237
v_sub_f32 v238, v238, v4
v_exp_f32 v238, v238
v_sub_f32 v239, v239, v4
v_exp_f32 v239, v239
v_cvt_pk_bf16_f32 v24, v224, v225
v_cvt_pk_bf16_f32 v25, v226, v227
v_cvt_pk_bf16_f32 v26, v228, v229
v_cvt_pk_bf16_f32 v27, v230, v231
v_cvt_pk_bf16_f32 v28, v232, v233
v_cvt_pk_bf16_f32 v29, v234, v235
v_cvt_pk_bf16_f32 v30, v236, v237
v_cvt_pk_bf16_f32 v31, v238, v239
v_mfma_f32_32x32x16_bf16 v[32:47], v[208:211], v[24:27], v[32:47]
s_nop 0
v_mfma_f32_32x32x16_bf16 v[32:47], v[212:215], v[28:31], v[32:47]
L_slow_e1:
s_nop 15
v_rcp_f32 v6, v56
s_nop 0
v_pk_mul_f32 v[48:49], v[48:49], v[6:7] op_sel_hi:[1,0]
v_pk_mul_f32 v[50:51], v[50:51], v[6:7] op_sel_hi:[1,0]
v_pk_mul_f32 v[52:53], v[52:53], v[6:7] op_sel_hi:[1,0]
v_pk_mul_f32 v[54:55], v[54:55], v[6:7] op_sel_hi:[1,0]
v_cvt_pk_bf16_f32 v56, v48, v49
v_cvt_pk_bf16_f32 v57, v50, v51
v_cvt_pk_bf16_f32 v58, v52, v53
v_cvt_pk_bf16_f32 v59, v54, v55
v_add3_u32 v60, s6, v56, v57
v_add3_u32 v60, v60, v58, v59
s_branch L_attn_norm
L_end:
s_endpgm
.section .rodata,"a"
.p2align 6
.amdhsa_kernel sequential_preLN__sliding_block__moe_arch_mod__prompt_kernel
  .amdhsa_next_free_vgpr 256
  .amdhsa_next_free_sgpr 102
  .amdhsa_accum_offset 256
  .amdhsa_group_segment_fixed_size 0
  .amdhsa_kernarg_size 88
  .amdhsa_user_sgpr_count 2
  .amdhsa_user_sgpr_kernarg_segment_ptr 1
  .amdhsa_system_sgpr_workgroup_id_x 1
.end_amdhsa_kernel
```
